```python
import torch

def _softmax(x, axis=-1):
    return torch.softmax(x, dim=axis)
def _gelu(x):
    return torch.nn.functional.gelu(x, approximate="tanh")
def _silu(x):
    return torch.nn.functional.silu(x)
def _sigmoid(x):
    return torch.sigmoid(x)
def _layernorm(x, axis=-1, eps=1e-5):
    m = x.mean(dim=axis, keepdim=True)
    v = x.var(dim=axis, keepdim=True, unbiased=False)
    return (x - m) / torch.sqrt(v + eps)
def _scatter_add(tgt, idx, src, axis=0):
    return tgt.clone().index_add_(axis, idx, src)
def _segment_sum(src, seg, n):
    out = torch.zeros((n,) + src.shape[1:], dtype=src.dtype)
    return out.index_add_(0, seg, src)
def _pad(x, pw):
    flat = tuple(v for pair in reversed(pw) for v in pair)
    return torch.nn.functional.pad(x, flat)

kernel_name = 'concat_heads__ssm_conv_s4d__linear_kernel_hedgehog__prompt'

def setup_inputs():

    _w = (lambda a: (lambda t: t.to(torch.bfloat16) if t.is_floating_point() else t)(torch.as_tensor(a)))
    def _A_setup():
        Bsz, L, D, N = 1, 2048, 640, 128
        return {
            "u": _w((lambda *s: torch.randn(*s, dtype=torch.bfloat16) * 0.05)(Bsz, L, D)),
            "log_A_real": _w((lambda *s: torch.randn(*s, dtype=torch.bfloat16) * 3.2)(D, N) * 0.5),
            "A_imag": _w((lambda *s: torch.randn(*s, dtype=torch.bfloat16) * 0.1)(D, N) * 3.14),
            "C_real": _w((lambda *s: torch.randn(*s, dtype=torch.bfloat16) * 1.6)(D, N) / N ** 0.5),
            "C_imag": _w((lambda *s: torch.randn(*s, dtype=torch.bfloat16) * 1.6)(D, N) / N ** 0.5),
            "log_dt": _w((lambda *s: torch.randn(*s, dtype=torch.bfloat16) * 0.1)(D) * 0.5 - 4.0),
            "D_skip": _w((lambda *s: torch.randn(*s, dtype=torch.bfloat16) * 0.1)(D)),
        }
    _A_in = _A_setup()

    def _B_setup():
        B, S, D, H = 1, 2048, 640, 32
        Dh = D // H
        return {
            "x": _w((lambda *s: torch.randn(*s, dtype=torch.bfloat16) * 0.4)(B, S, D)),
            "wqkv": _w((lambda *s: torch.randn(*s, dtype=torch.bfloat16) * 0.4)(D, 3 * D)),
            "w_phi": _w((lambda *s: torch.randn(*s, dtype=torch.bfloat16) * 0.4)(H, Dh, Dh) * (Dh ** -0.5)),
            "wo": _w((lambda *s: torch.randn(*s, dtype=torch.bfloat16) * 0.05)(D, D)),
        }
    _B_in = _B_setup()

    return {
        "A_u": _A_in["u"],
        "A_log_A_real": _A_in["log_A_real"],
        "A_A_imag": _A_in["A_imag"],
        "A_C_real": _A_in["C_real"],
        "A_C_imag": _A_in["C_imag"],
        "A_log_dt": _A_in["log_dt"],
        "A_D_skip": _A_in["D_skip"],
        "B_x": _B_in["x"],
        "B_wqkv": _B_in["wqkv"],
        "B_w_phi": _B_in["w_phi"],
        "B_wo": _B_in["wo"],
    }

def reference(A_u, A_log_A_real, A_A_imag, A_C_real, A_C_imag, A_log_dt, A_D_skip, B_x, B_wqkv, B_w_phi, B_wo):
    def _A_ref(u, log_A_real, A_imag, C_real, C_imag, log_dt, D_skip):
        L = u.shape[1]
        dt = torch.exp(log_dt)
        A = -torch.exp(log_A_real) + 1j * A_imag
        C = (C_real + 1j * C_imag) * dt[:, None]
        pos = (lambda x, dt: x.to(dt))(torch.arange(L), log_dt.dtype)
        P = torch.exp((A * dt[:, None])[:, :, None] * pos[None, None, :])
        K = 2.0 * torch.einsum("dn,dnl->dl", C, P).real
        L2 = 2 * L
        u_t = (lambda x, *d: x.permute(*d))(u, 0, 2, 1)
        Kf = (lambda x, *a, **k: torch.fft.rfft(x.float(), *a, **k))(K, L2)
        Uf = (lambda x, *a, **k: torch.fft.rfft(x.float(), *a, **k))(u_t, L2)
        y = (lambda x, *a, **k: torch.fft.irfft(x, *a, **k).to(torch.bfloat16))(Uf * Kf[None, :, :], L2)[:, :, :L]
        y = (lambda x, *d: x.permute(*d))(y, 0, 2, 1)
        return y + u * D_skip[None, None, :]

    def _B_ref(x, wqkv, w_phi, wo):
        B, S, D = x.shape
        H = 32; Dh = D // H
        qkv = (lambda x, *d: x.permute(*d))((x @ wqkv).reshape(B, S, 3, H, Dh), 2, 0, 3, 1, 4)
        q, k, v = qkv[0], qkv[1], qkv[2]
        pq = torch.einsum("bhsd,hdf->bhsf", q, w_phi)
        pk = torch.einsum("bhsd,hdf->bhsf", k, w_phi)
        phi_q = torch.concatenate([_softmax(pq, axis=-1), _softmax(-pq, axis=-1)], axis=-1)
        phi_k = torch.concatenate([_softmax(pk, axis=-1), _softmax(-pk, axis=-1)], axis=-1)
        kv = torch.einsum("bhsf,bhsd->bhfd", phi_k, v)
        z  = torch.einsum("bhsf->bhf", phi_k)
        num = torch.einsum("bhqf,bhfd->bhqd", phi_q, kv)
        den = torch.einsum("bhqf,bhf->bhq", phi_q, z)[..., None] + 1e-6
        o = num / den
        return (lambda x, *d: x.permute(*d))(o, 0, 2, 1, 3).reshape(B, S, D) @ wo

    a = _A_ref(A_u, A_log_A_real, A_A_imag, A_C_real, A_C_imag, A_log_dt, A_D_skip)
    b = _B_ref(B_x, B_wqkv, B_w_phi, B_wo)
    return torch.concatenate([a, b], axis=-1)
```

```asm
; @launch grid=(256,1,1) block=(768,1,1) lds=163840
.amdgcn_target "amdgcn-amd-amdhsa--gfx950"
.text
.globl concat_heads__ssm_conv_s4d__linear_kernel_hedgehog__prompt_kernel
.p2align 8
.type concat_heads__ssm_conv_s4d__linear_kernel_hedgehog__prompt_kernel,@function
concat_heads__ssm_conv_s4d__linear_kernel_hedgehog__prompt_kernel:
    s_cmp_ge_u32 s2, 256
    s_cbranch_scc1 L_end
    s_load_dwordx16 s[4:19], s[0:1], 0
    s_load_dwordx8 s[20:27], s[0:1], 64
    s_load_dwordx4 s[28:31], s[0:1], 96
    s_cmp_lt_u32 s2, 176
    s_cbranch_scc1 L_partb
    s_sub_u32 s32, s2, 176
    s_and_b32 s33, s32, 7
    s_lshr_b32 s52, s32, 3
    s_mul_i32 s34, s33, 10
    s_add_u32 s34, s34, s52
    v_lshrrev_b32 v2, 6, v0
    v_and_b32 v1, 63, v0
    v_readfirstlane_b32 s35, v2
    s_nop 3
    s_cmp_ge_u32 s35, 8
    s_cbranch_scc1 L_end
    s_mov_b32 s38, 0x3fb8aa3b
    s_mov_b32 s39, 0x32a57060
    s_mov_b32 s40, 0x3f317218
    s_mov_b32 s41, 0x07060100
    s_lshl_b32 s36, s34, 3
    s_add_u32 s36, s36, s35
    s_mul_i32 s37, s35, 20416
    s_waitcnt lgkmcnt(0)
    s_mov_b32 s44, s4
    s_and_b32 s45, s5, 0xffff
    s_mov_b32 s46, 2621440
    s_mov_b32 s47, 0x00020000
    s_mov_b32 s48, s26
    s_and_b32 s49, s27, 0xffff
    s_mov_b32 s50, 5242880
    s_mov_b32 s51, 0x00020000
    s_lshl_b32 s52, s36, 8
    v_lshl_add_u32 v9, v1, 2, s52
    s_lshl_b32 s53, s36, 1
    v_mov_b32 v2, s53
    global_load_ushort v7, v2, s[14:15]
    global_load_dword v3, v9, s[6:7]
    global_load_dword v4, v9, s[8:9]
    global_load_dword v5, v9, s[10:11]
    global_load_dword v6, v9, s[12:13]
    global_load_ushort v8, v2, s[16:17]
    v_mul_u32_u24 v9, 5120, v0
    s_lshl_b32 s52, s34, 4
    v_add_u32 v9, s52, v9
    v_subrev_u32 v10, 1280, v9
    v_lshlrev_b32 v11, 2, v1
    v_xor_b32 v32, 0, v11
    v_add_u32 v32, s37, v32
    v_xor_b32 v33, 16, v11
    v_add_u32 v33, s37, v33
    v_xor_b32 v34, 32, v11
    v_add_u32 v34, s37, v34
    v_xor_b32 v35, 48, v11
    v_add_u32 v35, s37, v35
    v_xor_b32 v36, 64, v11
    v_add_u32 v36, s37, v36
    v_xor_b32 v37, 80, v11
    v_add_u32 v37, s37, v37
    v_xor_b32 v38, 96, v11
    v_add_u32 v38, s37, v38
    v_xor_b32 v39, 112, v11
    v_add_u32 v39, s37, v39
    v_xor_b32 v40, 128, v11
    v_add_u32 v40, s37, v40
    v_xor_b32 v41, 144, v11
    v_add_u32 v41, s37, v41
    v_xor_b32 v42, 160, v11
    v_add_u32 v42, s37, v42
    v_xor_b32 v43, 176, v11
    v_add_u32 v43, s37, v43
    v_xor_b32 v44, 192, v11
    v_add_u32 v44, s37, v44
    v_xor_b32 v45, 208, v11
    v_add_u32 v45, s37, v45
    v_xor_b32 v46, 224, v11
    v_add_u32 v46, s37, v46
    v_xor_b32 v47, 240, v11
    v_add_u32 v47, s37, v47
    v_and_b32 v52, 15, v1
    v_lshrrev_b32 v53, 4, v1
    v_add_u32 v2, 0, v53
    v_xor_b32 v2, v2, v52
    v_lshlrev_b32 v2, 4, v2
    v_lshl_add_u32 v2, v52, 8, v2
    v_add_u32 v48, s37, v2
    v_add_u32 v2, 4, v53
    v_xor_b32 v2, v2, v52
    v_lshlrev_b32 v2, 4, v2
    v_lshl_add_u32 v2, v52, 8, v2
    v_add_u32 v49, s37, v2
    v_add_u32 v2, 8, v53
    v_xor_b32 v2, v2, v52
    v_lshlrev_b32 v2, 4, v2
    v_lshl_add_u32 v2, v52, 8, v2
    v_add_u32 v50, s37, v2
    v_add_u32 v2, 12, v53
    v_xor_b32 v2, v2, v52
    v_lshlrev_b32 v2, 4, v2
    v_lshl_add_u32 v2, v52, 8, v2
    v_add_u32 v51, s37, v2
    s_waitcnt vmcnt(0)
    v_lshlrev_b32 v7, 16, v7
    v_mul_f32 v11, s38, v7
    v_fma_f32 v54, v7, s38, -v11
    v_fma_f32 v54, v7, s39, v54
    v_exp_f32 v11, v11
    v_mul_f32 v54, s40, v54
    v_fma_f32 v11, v11, v54, v11
    v_cvt_pk_bf16_f32 v11, v11, v11
    v_lshlrev_b32 v7, 16, v11
    v_lshlrev_b32 v8, 16, v8
    v_mov_b32 v56, 0
    v_mov_b32 v57, 0
    v_mov_b32 v58, 0
    v_mov_b32 v59, 0
    v_mov_b32 v60, 0
    v_mov_b32 v61, 0
    v_mov_b32 v62, 0
    v_mov_b32 v63, 0
    v_mov_b32 v64, 0
    v_mov_b32 v65, 0
    v_mov_b32 v66, 0
    v_mov_b32 v67, 0
    s_mov_b32 s58, 0
L_a_pass:
    v_lshrrev_b32 v55, s58, v3
    v_lshrrev_b32 v90, s58, v4
    v_lshrrev_b32 v91, s58, v5
    v_lshrrev_b32 v92, s58, v6
    v_lshlrev_b32 v55, 16, v55
    v_lshlrev_b32 v90, 16, v90
    v_lshlrev_b32 v91, 16, v91
    v_lshlrev_b32 v92, 16, v92
    v_mul_f32 v93, s38, v55
    v_fma_f32 v94, v55, s38, -v93
    v_fma_f32 v94, v55, s39, v94
    v_exp_f32 v93, v93
    v_mul_f32 v94, s40, v94
    v_fma_f32 v93, v93, v94, v93
    v_cvt_pk_bf16_f32 v93, v93, v93
    v_lshlrev_b32 v55, 16, v93
    v_mul_f32 v55, v55, v7
    v_mul_f32 v90, v90, v7
    v_mul_f32 v11, s38, v55
    v_mul_f32 v54, 0.15915494, v90
    v_sub_f32 v11, 0, v11
    v_mul_f32 v91, v91, v7
    v_mul_f32 v92, v92, v7
    v_add_f32 v78, v91, v91
    v_add_f32 v79, v92, v92
    s_cmp_eq_u32 s58, 0
    s_cbranch_scc1 L_a_nou0
    buffer_load_dwordx4 v[12:15], v10, s[44:47], 0 offen
L_a_nou0:
    v_mul_f32 v55, 1.0, v11
    v_mul_f32 v90, 1.0, v54
    v_fract_f32 v90, v90
    v_exp_f32 v55, v55
    v_cos_f32 v68, v90
    v_sin_f32 v69, v90
    v_mul_f32 v68, v68, v55
    v_mul_f32 v69, v69, v55
    v_mul_f32 v55, 0x41000000, v11
    v_mul_f32 v90, 0x41000000, v54
    v_fract_f32 v90, v90
    v_exp_f32 v55, v55
    v_cos_f32 v74, v90
    v_sin_f32 v75, v90
    v_mul_f32 v74, v74, v55
    v_mul_f32 v75, v75, v55
    v_mul_f32 v55, 0x43000000, v11
    v_mul_f32 v90, 0x43000000, v54
    v_fract_f32 v90, v90
    v_exp_f32 v55, v55
    v_cos_f32 v76, v90
    v_sin_f32 v77, v90
    v_mul_f32 v76, v76, v55
    v_mul_f32 v77, v77, v55
    v_pk_mul_f32 v[70:71], v[68:69], v[68:69] op_sel:[0,0] op_sel_hi:[1,0]
    v_fma_f32 v70, -v69, v69, v70
    v_fma_f32 v71, v68, v69, v71
    v_pk_mul_f32 v[72:73], v[70:71], v[70:71] op_sel:[0,0] op_sel_hi:[1,0]
    v_fma_f32 v72, -v71, v71, v72
    v_fma_f32 v73, v70, v71, v73
    v_mov_b32 v55, 0x00003f80
    ds_write_b32 v32, v55
    v_cvt_pk_bf16_f32 v90, v74, -v75
    ds_write_b32 v33, v90 offset:256
    v_pk_mul_f32 v[82:83], v[74:75], v[74:75] op_sel:[0,0] op_sel_hi:[1,0]
    v_fma_f32 v82, -v75, v75, v82
    v_fma_f32 v83, v74, v75, v83
    v_cvt_pk_bf16_f32 v91, v82, -v83
    ds_write_b32 v34, v91 offset:512
    v_pk_mul_f32 v[84:85], v[82:83], v[74:75] op_sel:[0,0] op_sel_hi:[1,0]
    v_fma_f32 v84, -v83, v75, v84
    v_fma_f32 v85, v82, v75, v85
    v_cvt_pk_bf16_f32 v92, v84, -v85
    ds_write_b32 v35, v92 offset:768
    v_pk_mul_f32 v[82:83], v[84:85], v[74:75] op_sel:[0,0] op_sel_hi:[1,0]
    v_fma_f32 v82, -v85, v75, v82
    v_fma_f32 v83, v84, v75, v83
    v_cvt_pk_bf16_f32 v55, v82, -v83
    ds_write_b32 v36, v55 offset:1024
    v_pk_mul_f32 v[84:85], v[82:83], v[74:75] op_sel:[0,0] op_sel_hi:[1,0]
    v_fma_f32 v84, -v83, v75, v84
    v_fma_f32 v85, v82, v75, v85
    v_cvt_pk_bf16_f32 v90, v84, -v85
    ds_write_b32 v37, v90 offset:1280
    v_pk_mul_f32 v[82:83], v[84:85], v[74:75] op_sel:[0,0] op_sel_hi:[1,0]
    v_fma_f32 v82, -v85, v75, v82
    v_fma_f32 v83, v84, v75, v83
    v_cvt_pk_bf16_f32 v91, v82, -v83
    ds_write_b32 v38, v91 offset:1536
    v_pk_mul_f32 v[84:85], v[82:83], v[74:75] op_sel:[0,0] op_sel_hi:[1,0]
    v_fma_f32 v84, -v83, v75, v84
    v_fma_f32 v85, v82, v75, v85
    v_cvt_pk_bf16_f32 v92, v84, -v85
    ds_write_b32 v39, v92 offset:1792
    v_pk_mul_f32 v[82:83], v[84:85], v[74:75] op_sel:[0,0] op_sel_hi:[1,0]
    v_fma_f32 v82, -v85, v75, v82
    v_fma_f32 v83, v84, v75, v83
    v_cvt_pk_bf16_f32 v55, v82, -v83
    ds_write_b32 v40, v55 offset:2048
    v_pk_mul_f32 v[84:85], v[82:83], v[74:75] op_sel:[0,0] op_sel_hi:[1,0]
    v_fma_f32 v84, -v83, v75, v84
    v_fma_f32 v85, v82, v75, v85
    v_cvt_pk_bf16_f32 v90, v84, -v85
    ds_write_b32 v41, v90 offset:2304
    v_pk_mul_f32 v[82:83], v[84:85], v[74:75] op_sel:[0,0] op_sel_hi:[1,0]
    v_fma_f32 v82, -v85, v75, v82
    v_fma_f32 v83, v84, v75, v83
    v_cvt_pk_bf16_f32 v91, v82, -v83
    ds_write_b32 v42, v91 offset:2560
    v_pk_mul_f32 v[84:85], v[82:83], v[74:75] op_sel:[0,0] op_sel_hi:[1,0]
    v_fma_f32 v84, -v83, v75, v84
    v_fma_f32 v85, v82, v75, v85
    v_cvt_pk_bf16_f32 v92, v84, -v85
    ds_write_b32 v43, v92 offset:2816
    v_pk_mul_f32 v[82:83], v[84:85], v[74:75] op_sel:[0,0] op_sel_hi:[1,0]
    v_fma_f32 v82, -v85, v75, v82
    v_fma_f32 v83, v84, v75, v83
    v_cvt_pk_bf16_f32 v55, v82, -v83
    ds_write_b32 v44, v55 offset:3072
    v_pk_mul_f32 v[84:85], v[82:83], v[74:75] op_sel:[0,0] op_sel_hi:[1,0]
    v_fma_f32 v84, -v83, v75, v84
    v_fma_f32 v85, v82, v75, v85
    v_cvt_pk_bf16_f32 v90, v84, -v85
    ds_write_b32 v45, v90 offset:3328
    v_pk_mul_f32 v[82:83], v[84:85], v[74:75] op_sel:[0,0] op_sel_hi:[1,0]
    v_fma_f32 v82, -v85, v75, v82
    v_fma_f32 v83, v84, v75, v83
    v_cvt_pk_bf16_f32 v91, v82, -v83
    ds_write_b32 v46, v91 offset:3584
    v_pk_mul_f32 v[84:85], v[82:83], v[74:75] op_sel:[0,0] op_sel_hi:[1,0]
    v_fma_f32 v84, -v83, v75, v84
    v_fma_f32 v85, v82, v75, v85
    v_cvt_pk_bf16_f32 v92, v84, -v85
    ds_write_b32 v47, v92 offset:3840
    s_cmp_eq_u32 s58, 0
    s_cbranch_scc1 L_a_nou1
    buffer_load_dwordx4 v[16:19], v9, s[44:47], 0 offen offset:0
L_a_nou1:
    v_cvt_pk_bf16_f32 v55, v78, v79
    ds_write_b32 v32, v55 offset:4096
    v_pk_mul_f32 v[88:89], v[78:79], v[68:69] op_sel:[0,0] op_sel_hi:[1,0]
    v_fma_f32 v88, -v79, v69, v88
    v_fma_f32 v89, v78, v69, v89
    v_cvt_pk_bf16_f32 v90, v88, v89
    ds_write_b32 v33, v90 offset:4352
    v_pk_mul_f32 v[86:87], v[88:89], v[68:69] op_sel:[0,0] op_sel_hi:[1,0]
    v_fma_f32 v86, -v89, v69, v86
    v_fma_f32 v87, v88, v69, v87
    v_cvt_pk_bf16_f32 v91, v86, v87
    ds_write_b32 v34, v91 offset:4608
    v_pk_mul_f32 v[88:89], v[86:87], v[68:69] op_sel:[0,0] op_sel_hi:[1,0]
    v_fma_f32 v88, -v87, v69, v88
    v_fma_f32 v89, v86, v69, v89
    v_cvt_pk_bf16_f32 v92, v88, v89
    ds_write_b32 v35, v92 offset:4864
    v_pk_mul_f32 v[86:87], v[88:89], v[68:69] op_sel:[0,0] op_sel_hi:[1,0]
    v_fma_f32 v86, -v89, v69, v86
    v_fma_f32 v87, v88, v69, v87
    v_cvt_pk_bf16_f32 v55, v86, v87
    ds_write_b32 v36, v55 offset:5120
    v_pk_mul_f32 v[88:89], v[86:87], v[68:69] op_sel:[0,0] op_sel_hi:[1,0]
    v_fma_f32 v88, -v87, v69, v88
    v_fma_f32 v89, v86, v69, v89
    v_cvt_pk_bf16_f32 v90, v88, v89
    ds_write_b32 v37, v90 offset:5376
    v_pk_mul_f32 v[86:87], v[88:89], v[68:69] op_sel:[0,0] op_sel_hi:[1,0]
    v_fma_f32 v86, -v89, v69, v86
    v_fma_f32 v87, v88, v69, v87
    v_cvt_pk_bf16_f32 v91, v86, v87
    ds_write_b32 v38, v91 offset:5632
    v_pk_mul_f32 v[88:89], v[86:87], v[68:69] op_sel:[0,0] op_sel_hi:[1,0]
    v_fma_f32 v88, -v87, v69, v88
    v_fma_f32 v89, v86, v69, v89
    v_cvt_pk_bf16_f32 v92, v88, v89
    ds_write_b32 v39, v92 offset:5888
    s_cmp_eq_u32 s58, 0
    s_cbranch_scc1 L_a_nou2
    buffer_load_dwordx4 v[20:23], v9, s[44:47], 0 offen offset:1280
L_a_nou2:
    v_pk_mul_f32 v[80:81], v[78:79], v[76:77] op_sel:[0,0] op_sel_hi:[1,0]
    v_fma_f32 v80, -v79, v77, v80
    v_fma_f32 v81, v78, v77, v81
    v_cvt_pk_bf16_f32 v55, v80, v81
    ds_write_b32 v40, v55 offset:6144
    v_pk_mul_f32 v[88:89], v[80:81], v[68:69] op_sel:[0,0] op_sel_hi:[1,0]
    v_fma_f32 v88, -v81, v69, v88
    v_fma_f32 v89, v80, v69, v89
    v_cvt_pk_bf16_f32 v90, v88, v89
    ds_write_b32 v41, v90 offset:6400
    v_pk_mul_f32 v[86:87], v[88:89], v[68:69] op_sel:[0,0] op_sel_hi:[1,0]
    v_fma_f32 v86, -v89, v69, v86
    v_fma_f32 v87, v88, v69, v87
    v_cvt_pk_bf16_f32 v91, v86, v87
    ds_write_b32 v42, v91 offset:6656
    v_pk_mul_f32 v[88:89], v[86:87], v[68:69] op_sel:[0,0] op_sel_hi:[1,0]
    v_fma_f32 v88, -v87, v69, v88
    v_fma_f32 v89, v86, v69, v89
    v_cvt_pk_bf16_f32 v92, v88, v89
    ds_write_b32 v43, v92 offset:6912
    v_pk_mul_f32 v[86:87], v[88:89], v[68:69] op_sel:[0,0] op_sel_hi:[1,0]
    v_fma_f32 v86, -v89, v69, v86
    v_fma_f32 v87, v88, v69, v87
    v_cvt_pk_bf16_f32 v55, v86, v87
    ds_write_b32 v44, v55 offset:7168
    v_pk_mul_f32 v[88:89], v[86:87], v[68:69] op_sel:[0,0] op_sel_hi:[1,0]
    v_fma_f32 v88, -v87, v69, v88
    v_fma_f32 v89, v86, v69, v89
    v_cvt_pk_bf16_f32 v90, v88, v89
    ds_write_b32 v45, v90 offset:7424
    v_pk_mul_f32 v[86:87], v[88:89], v[68:69] op_sel:[0,0] op_sel_hi:[1,0]
    v_fma_f32 v86, -v89, v69, v86
    v_fma_f32 v87, v88, v69, v87
    v_cvt_pk_bf16_f32 v91, v86, v87
    ds_write_b32 v46, v91 offset:7680
    v_pk_mul_f32 v[88:89], v[86:87], v[68:69] op_sel:[0,0] op_sel_hi:[1,0]
    v_fma_f32 v88, -v87, v69, v88
    v_fma_f32 v89, v86, v69, v89
    v_cvt_pk_bf16_f32 v92, v88, v89
    ds_write_b32 v47, v92 offset:7936
    s_cmp_eq_u32 s58, 0
    s_cbranch_scc1 L_a_nou3
    buffer_load_dwordx4 v[24:27], v9, s[44:47], 0 offen offset:2560
L_a_nou3:
    v_pk_mul_f32 v[78:79], v[80:81], v[76:77] op_sel:[0,0] op_sel_hi:[1,0]
    v_fma_f32 v78, -v81, v77, v78
    v_fma_f32 v79, v80, v77, v79
    v_cvt_pk_bf16_f32 v55, v78, v79
    ds_write_b32 v32, v55 offset:8192
    v_pk_mul_f32 v[88:89], v[78:79], v[70:71] op_sel:[0,0] op_sel_hi:[1,0]
    v_fma_f32 v88, -v79, v71, v88
    v_fma_f32 v89, v78, v71, v89
    v_cvt_pk_bf16_f32 v90, v88, v89
    ds_write_b32 v33, v90 offset:8448
    v_pk_mul_f32 v[86:87], v[88:89], v[70:71] op_sel:[0,0] op_sel_hi:[1,0]
    v_fma_f32 v86, -v89, v71, v86
    v_fma_f32 v87, v88, v71, v87
    v_cvt_pk_bf16_f32 v91, v86, v87
    ds_write_b32 v34, v91 offset:8704
    v_pk_mul_f32 v[88:89], v[86:87], v[70:71] op_sel:[0,0] op_sel_hi:[1,0]
    v_fma_f32 v88, -v87, v71, v88
    v_fma_f32 v89, v86, v71, v89
    v_cvt_pk_bf16_f32 v92, v88, v89
    ds_write_b32 v35, v92 offset:8960
    v_pk_mul_f32 v[80:81], v[78:79], v[76:77] op_sel:[0,0] op_sel_hi:[1,0]
    v_fma_f32 v80, -v79, v77, v80
    v_fma_f32 v81, v78, v77, v81
    v_cvt_pk_bf16_f32 v55, v80, v81
    ds_write_b32 v36, v55 offset:9216
    v_pk_mul_f32 v[88:89], v[80:81], v[70:71] op_sel:[0,0] op_sel_hi:[1,0]
    v_fma_f32 v88, -v81, v71, v88
    v_fma_f32 v89, v80, v71, v89
    v_cvt_pk_bf16_f32 v90, v88, v89
    ds_write_b32 v37, v90 offset:9472
    v_pk_mul_f32 v[86:87], v[88:89], v[70:71] op_sel:[0,0] op_sel_hi:[1,0]
    v_fma_f32 v86, -v89, v71, v86
    v_fma_f32 v87, v88, v71, v87
    v_cvt_pk_bf16_f32 v91, v86, v87
    ds_write_b32 v38, v91 offset:9728
    v_pk_mul_f32 v[88:89], v[86:87], v[70:71] op_sel:[0,0] op_sel_hi:[1,0]
    v_fma_f32 v88, -v87, v71, v88
    v_fma_f32 v89, v86, v71, v89
    v_cvt_pk_bf16_f32 v92, v88, v89
    ds_write_b32 v39, v92 offset:9984
    v_pk_mul_f32 v[78:79], v[80:81], v[76:77] op_sel:[0,0] op_sel_hi:[1,0]
    v_fma_f32 v78, -v81, v77, v78
    v_fma_f32 v79, v80, v77, v79
    v_cvt_pk_bf16_f32 v55, v78, v79
    ds_write_b32 v40, v55 offset:10240
    v_pk_mul_f32 v[86:87], v[78:79], v[72:73] op_sel:[0,0] op_sel_hi:[1,0]
    v_fma_f32 v86, -v79, v73, v86
    v_fma_f32 v87, v78, v73, v87
    v_cvt_pk_bf16_f32 v90, v86, v87
    ds_write_b32 v41, v90 offset:10496
    v_pk_mul_f32 v[80:81], v[78:79], v[76:77] op_sel:[0,0] op_sel_hi:[1,0]
    v_fma_f32 v80, -v79, v77, v80
    v_fma_f32 v81, v78, v77, v81
    v_cvt_pk_bf16_f32 v91, v80, v81
    ds_write_b32 v42, v91 offset:10752
    v_pk_mul_f32 v[86:87], v[80:81], v[72:73] op_sel:[0,0] op_sel_hi:[1,0]
    v_fma_f32 v86, -v81, v73, v86
    v_fma_f32 v87, v80, v73, v87
    v_cvt_pk_bf16_f32 v92, v86, v87
    ds_write_b32 v43, v92 offset:11008
    v_pk_mul_f32 v[78:79], v[80:81], v[76:77] op_sel:[0,0] op_sel_hi:[1,0]
    v_fma_f32 v78, -v81, v77, v78
    v_fma_f32 v79, v80, v77, v79
    v_cvt_pk_bf16_f32 v55, v78, v79
    ds_write_b32 v44, v55 offset:11264
    v_pk_mul_f32 v[86:87], v[78:79], v[72:73] op_sel:[0,0] op_sel_hi:[1,0]
    v_fma_f32 v86, -v79, v73, v86
    v_fma_f32 v87, v78, v73, v87
    v_cvt_pk_bf16_f32 v90, v86, v87
    ds_write_b32 v45, v90 offset:11520
    v_pk_mul_f32 v[80:81], v[78:79], v[76:77] op_sel:[0,0] op_sel_hi:[1,0]
    v_fma_f32 v80, -v79, v77, v80
    v_fma_f32 v81, v78, v77, v81
    v_cvt_pk_bf16_f32 v91, v80, v81
    ds_write_b32 v46, v91 offset:11776
    v_pk_mul_f32 v[86:87], v[80:81], v[72:73] op_sel:[0,0] op_sel_hi:[1,0]
    v_fma_f32 v86, -v81, v73, v86
    v_fma_f32 v87, v80, v73, v87
    v_cvt_pk_bf16_f32 v92, v86, v87
    ds_write_b32 v47, v92 offset:12032
    s_cmp_eq_u32 s58, 0
    s_cbranch_scc1 L_a_nou4
    buffer_load_dwordx4 v[28:31], v9, s[44:47], 0 offen offset:3840
L_a_nou4:
    v_pk_mul_f32 v[78:79], v[80:81], v[76:77] op_sel:[0,0] op_sel_hi:[1,0]
    v_fma_f32 v78, -v81, v77, v78
    v_fma_f32 v79, v80, v77, v79
    v_cvt_pk_bf16_f32 v55, v78, v79
    ds_write_b32 v32, v55 offset:12288
    v_pk_mul_f32 v[80:81], v[78:79], v[76:77] op_sel:[0,0] op_sel_hi:[1,0]
    v_fma_f32 v80, -v79, v77, v80
    v_fma_f32 v81, v78, v77, v81
    v_cvt_pk_bf16_f32 v90, v80, v81
    ds_write_b32 v33, v90 offset:12544
    v_pk_mul_f32 v[78:79], v[80:81], v[76:77] op_sel:[0,0] op_sel_hi:[1,0]
    v_fma_f32 v78, -v81, v77, v78
    v_fma_f32 v79, v80, v77, v79
    v_cvt_pk_bf16_f32 v91, v78, v79
    ds_write_b32 v34, v91 offset:12800
    v_pk_mul_f32 v[80:81], v[78:79], v[76:77] op_sel:[0,0] op_sel_hi:[1,0]
    v_fma_f32 v80, -v79, v77, v80
    v_fma_f32 v81, v78, v77, v81
    v_cvt_pk_bf16_f32 v92, v80, v81
    ds_write_b32 v35, v92 offset:13056
    v_pk_mul_f32 v[78:79], v[80:81], v[76:77] op_sel:[0,0] op_sel_hi:[1,0]
    v_fma_f32 v78, -v81, v77, v78
    v_fma_f32 v79, v80, v77, v79
    v_cvt_pk_bf16_f32 v55, v78, v79
    ds_write_b32 v36, v55 offset:13312
    v_pk_mul_f32 v[80:81], v[78:79], v[76:77] op_sel:[0,0] op_sel_hi:[1,0]
    v_fma_f32 v80, -v79, v77, v80
    v_fma_f32 v81, v78, v77, v81
    v_cvt_pk_bf16_f32 v90, v80, v81
    ds_write_b32 v37, v90 offset:13568
    v_pk_mul_f32 v[78:79], v[80:81], v[76:77] op_sel:[0,0] op_sel_hi:[1,0]
    v_fma_f32 v78, -v81, v77, v78
    v_fma_f32 v79, v80, v77, v79
    v_cvt_pk_bf16_f32 v91, v78, v79
    ds_write_b32 v38, v91 offset:13824
    v_pk_mul_f32 v[80:81], v[78:79], v[76:77] op_sel:[0,0] op_sel_hi:[1,0]
    v_fma_f32 v80, -v79, v77, v80
    v_fma_f32 v81, v78, v77, v81
    v_cvt_pk_bf16_f32 v92, v80, v81
    ds_write_b32 v39, v92 offset:14080
    v_pk_mul_f32 v[78:79], v[80:81], v[76:77] op_sel:[0,0] op_sel_hi:[1,0]
    v_fma_f32 v78, -v81, v77, v78
    v_fma_f32 v79, v80, v77, v79
    v_cvt_pk_bf16_f32 v55, v78, v79
    ds_write_b32 v40, v55 offset:14336
    ds_read_b128 v[96:99], v48 offset:0
    ds_read_b128 v[100:103], v48 offset:4096
    ds_read_b128 v[104:107], v48 offset:8192
    ds_read_b128 v[108:111], v48 offset:12288
    ds_read_b128 v[112:115], v49 offset:0
    ds_read_b128 v[116:119], v49 offset:4096
    ds_read_b128 v[120:123], v49 offset:8192
    ds_read_b128 v[124:127], v49 offset:12288
    ds_read_b128 v[128:131], v50 offset:0
    ds_read_b128 v[132:135], v50 offset:4096
    ds_read_b128 v[136:139], v50 offset:8192
    ds_read_b128 v[140:143], v50 offset:12288
    ds_read_b128 v[144:147], v51 offset:0
    ds_read_b128 v[148:151], v51 offset:4096
    ds_read_b128 v[152:155], v51 offset:8192
    ds_read_b128 v[156:159], v51 offset:12288
    s_waitcnt lgkmcnt(12)
    v_mfma_f32_16x16x32_bf16 v[56:59], v[100:103], v[96:99], v[56:59]
    v_mfma_f32_16x16x32_bf16 v[60:63], v[104:107], v[96:99], v[60:63]
    v_mfma_f32_16x16x32_bf16 v[64:67], v[108:111], v[96:99], v[64:67]
    s_waitcnt lgkmcnt(8)
    v_mfma_f32_16x16x32_bf16 v[56:59], v[116:119], v[112:115], v[56:59]
    v_mfma_f32_16x16x32_bf16 v[60:63], v[120:123], v[112:115], v[60:63]
    v_mfma_f32_16x16x32_bf16 v[64:67], v[124:127], v[112:115], v[64:67]
    s_waitcnt lgkmcnt(4)
    v_mfma_f32_16x16x32_bf16 v[56:59], v[132:135], v[128:131], v[56:59]
    v_mfma_f32_16x16x32_bf16 v[60:63], v[136:139], v[128:131], v[60:63]
    v_mfma_f32_16x16x32_bf16 v[64:67], v[140:143], v[128:131], v[64:67]
    s_waitcnt lgkmcnt(0)
    v_mfma_f32_16x16x32_bf16 v[56:59], v[148:151], v[144:147], v[56:59]
    v_mfma_f32_16x16x32_bf16 v[60:63], v[152:155], v[144:147], v[60:63]
    v_mfma_f32_16x16x32_bf16 v[64:67], v[156:159], v[144:147], v[64:67]
    s_add_u32 s58, s58, 16
    s_cmp_le_u32 s58, 16
    s_cbranch_scc1 L_a_pass
    v_and_b32 v55, 1, v53
    v_lshrrev_b32 v90, 1, v53
    v_lshlrev_b32 v3, 5, v52
    v_lshl_add_u32 v3, v55, 4, v3
    v_lshl_add_u32 v3, v90, 9, v3
    v_add_u32 v3, s37, v3
    v_lshlrev_b32 v4, 4, v52
    v_lshl_add_u32 v4, v53, 8, v4
    v_add_u32 v4, 1024, v4
    v_add_u32 v5, 8, v4
    v_lshlrev_b32 v91, 3, v52
    v_lshl_add_u32 v91, v55, 8, v91
    v_add_u32 v91, 1536, v91
    v_add_u32 v92, 128, v91
    v_cmp_gt_u32 vcc, 2, v53
    s_nop 1
    v_cndmask_b32 v4, v91, v4, vcc
    v_cndmask_b32 v5, v92, v5, vcc
    v_add_u32 v4, s37, v4
    v_add_u32 v5, s37, v5
    v_lshlrev_b32 v6, 2, v52
    v_lshl_add_u32 v6, v53, 8, v6
    v_add_u32 v6, s37, v6
    v_mov_b32 v55, 0
    v_lshl_add_u32 v90, v1, 2, s37
    s_mov_b32 exec_lo, -1
    s_mov_b32 exec_hi, 0
    ds_write_b32 v90, v55 offset:8448
    s_mov_b64 exec, -1
    v_cvt_pk_bf16_f32 v96, v56, v56
    v_cvt_pk_bf16_f32 v97, v57, v57
    v_cvt_pk_bf16_f32 v98, v58, v58
    v_cvt_pk_bf16_f32 v99, v59, v59
    v_cvt_pk_bf16_f32 v100, v60, v60
    v_cvt_pk_bf16_f32 v101, v61, v61
    v_cvt_pk_bf16_f32 v102, v62, v62
    v_cvt_pk_bf16_f32 v103, v63, v63
    v_cvt_pk_bf16_f32 v104, v64, v64
    v_cvt_pk_bf16_f32 v105, v65, v65
    v_cvt_pk_bf16_f32 v106, v66, v66
    v_cvt_pk_bf16_f32 v107, v67, v67
    ds_write_b128 v3, v[96:99] offset:8576
    ds_write_b64 v4, v[100:101] offset:8576
    ds_write_b64 v5, v[102:103] offset:8576
    ds_write_b32 v6, v104 offset:10624
    ds_write_b32 v6, v105 offset:10688
    ds_write_b32 v6, v106 offset:10752
    ds_write_b32 v6, v107 offset:10816
    v_lshl_add_u32 v3, v1, 2, s37
    v_add_u32 v55, 10624, v3
    ds_read2_b32 v[4:5], v55 offset0:0 offset1:1
    ds_read2_b32 v[6:7], v55 offset0:64 offset1:65
    v_lshl_add_u32 v55, v1, 3, s37
    v_add_u32 v55, 10112, v55
    ds_read2_b32 v[32:33], v55 offset0:0 offset1:1
    ds_read_b32 v34, v55 offset:8
    v_lshl_add_u32 v55, v1, 4, s37
    v_add_u32 v55, 9600, v55
    ds_read_b128 v[36:39], v55
    ds_read_b32 v40, v55 offset:16
    v_lshl_add_u32 v55, v1, 5, s37
    v_add_u32 v55, 8448, v55
    ds_read_b128 v[56:59], v55
    ds_read_b128 v[60:63], v55 offset:16
    ds_read_b32 v64, v55 offset:32
    v_lshlrev_b32 v90, 3, v1
    v_subrev_u32 v90, 23, v90
    v_min_i32 v90, 256, v90
    v_lshlrev_b32 v90, 2, v90
    v_add_u32 v90, 8576, v90
    v_add_u32 v90, s37, v90
    ds_read_b32 v65, v90
    v_lshlrev_b32 v55, 4, v1
    v_sub_u32 v55, s37, v55
    v_add_u32 v11, 2032, v55
    v_add_u32 v42, 1008, v55
    v_add_u32 v43, 3056, v55
    v_add_u32 v44, 3568, v55
    v_add_u32 v45, 4144, v55
    v_and_b32 v55, 1, v1
    v_mov_b32 v90, 0x03020100
    v_mov_b32 v91, 0x07060100
    v_cmp_eq_u32 vcc, 1, v55
    s_nop 1
    v_cndmask_b32 v10, v91, v90, vcc
    s_waitcnt lgkmcnt(0)
    v_mov_b32 v68, v5
    v_mov_b32 v69, v5
    v_perm_b32 v70, v4, v5, v10
    v_mov_b32 v71, v4
    v_mov_b32 v72, v5
    v_perm_b32 v73, v4, v5, v10
    v_mov_b32 v74, v4
    v_mov_b32 v75, v4
    ds_write_b128 v11, v[68:71]
    ds_write_b128 v11, v[72:75] offset:4224
    v_mov_b32 v68, v7
    v_mov_b32 v69, v7
    v_perm_b32 v70, v6, v7, v10
    v_mov_b32 v71, v6
    v_mov_b32 v72, v7
    v_perm_b32 v73, v6, v7, v10
    v_mov_b32 v74, v6
    v_mov_b32 v75, v6
    ds_write_b128 v42, v[68:71]
    ds_write_b128 v42, v[72:75] offset:4224
    v_mov_b32 v68, v34
    v_mov_b32 v69, v34
    v_mov_b32 v70, v33
    v_perm_b32 v71, v32, v33, s41
    v_mov_b32 v72, v34
    v_mov_b32 v73, v33
    v_perm_b32 v74, v32, v33, s41
    v_mov_b32 v75, v32
    ds_write_b128 v43, v[68:71]
    ds_write_b128 v43, v[72:75] offset:4224
    s_mov_b32 exec_hi, 0
    v_mov_b32 v68, v40
    v_perm_b32 v69, v39, v40, s41
    v_mov_b32 v70, v38
    v_perm_b32 v71, v37, v38, s41
    v_perm_b32 v72, v39, v40, s41
    v_mov_b32 v73, v38
    v_perm_b32 v74, v37, v38, s41
    v_mov_b32 v75, v36
    ds_write_b128 v44, v[68:71]
    ds_write_b128 v44, v[72:75] offset:4224
    s_mov_b32 exec_hi, 15
    v_perm_b32 v68, v64, v65, s41
    v_perm_b32 v69, v62, v63, s41
    v_perm_b32 v70, v60, v61, s41
    v_perm_b32 v71, v58, v59, s41
    v_perm_b32 v72, v62, v63, s41
    v_perm_b32 v73, v60, v61, s41
    v_perm_b32 v74, v58, v59, s41
    v_perm_b32 v75, v56, v57, s41
    ds_write_b128 v45, v[68:71]
    ds_write_b128 v45, v[72:75] offset:4224
    s_mov_b64 exec, -1
    v_mov_b32 v4, 0
    v_mov_b32 v5, 0
    v_mov_b32 v6, 0
    v_mov_b32 v7, 0
    v_lshl_add_u32 v55, v1, 4, s37
    s_waitcnt lgkmcnt(0)
    s_mov_b32 exec_lo, 0xfffffff
    s_mov_b32 exec_hi, 0
    ds_write_b128 v55, v[4:7] offset:8384
    ds_write_b128 v55, v[4:7] offset:12960
    s_mov_b64 exec, -1
    s_waitcnt vmcnt(0) lgkmcnt(0)
    s_barrier
    s_mov_b32 s54, 0x05040100
    s_mov_b32 s55, 0x07060302
    v_lshlrev_b32 v55, 3, v0
    v_add_u32 v55, 8832, v55
    v_perm_b32 v32, v20, v16, s54
    v_perm_b32 v33, v28, v24, s54
    v_perm_b32 v34, v16, v12, s54
    v_perm_b32 v35, v24, v20, s54
    ds_write_b64 v55, v[32:33]
    ds_write_b64 v55, v[34:35] offset:4576
    v_add_u32 v55, 20416, v55
    v_perm_b32 v36, v20, v16, s55
    v_perm_b32 v37, v28, v24, s55
    v_perm_b32 v38, v16, v12, s55
    v_perm_b32 v39, v24, v20, s55
    ds_write_b64 v55, v[36:37]
    ds_write_b64 v55, v[38:39] offset:4576
    v_add_u32 v55, 20416, v55
    v_perm_b32 v32, v21, v17, s54
    v_perm_b32 v33, v29, v25, s54
    v_perm_b32 v34, v17, v13, s54
    v_perm_b32 v35, v25, v21, s54
    ds_write_b64 v55, v[32:33]
    ds_write_b64 v55, v[34:35] offset:4576
    v_add_u32 v55, 20416, v55
    v_perm_b32 v36, v21, v17, s55
    v_perm_b32 v37, v29, v25, s55
    v_perm_b32 v38, v17, v13, s55
    v_perm_b32 v39, v25, v21, s55
    ds_write_b64 v55, v[36:37]
    ds_write_b64 v55, v[38:39] offset:4576
    v_add_u32 v55, 20416, v55
    v_perm_b32 v32, v22, v18, s54
    v_perm_b32 v33, v30, v26, s54
    v_perm_b32 v34, v18, v14, s54
    v_perm_b32 v35, v26, v22, s54
    ds_write_b64 v55, v[32:33]
    ds_write_b64 v55, v[34:35] offset:4576
    v_add_u32 v55, 20416, v55
    v_perm_b32 v36, v22, v18, s55
    v_perm_b32 v37, v30, v26, s55
    v_perm_b32 v38, v18, v14, s55
    v_perm_b32 v39, v26, v22, s55
    ds_write_b64 v55, v[36:37]
    ds_write_b64 v55, v[38:39] offset:4576
    v_add_u32 v55, 20416, v55
    v_perm_b32 v32, v23, v19, s54
    v_perm_b32 v33, v31, v27, s54
    v_perm_b32 v34, v19, v15, s54
    v_perm_b32 v35, v27, v23, s54
    ds_write_b64 v55, v[32:33]
    ds_write_b64 v55, v[34:35] offset:4576
    v_add_u32 v55, 20416, v55
    v_perm_b32 v36, v23, v19, s55
    v_perm_b32 v37, v31, v27, s55
    v_perm_b32 v38, v19, v15, s55
    v_perm_b32 v39, v27, v23, s55
    ds_write_b64 v55, v[36:37]
    ds_write_b64 v55, v[38:39] offset:4576
    s_waitcnt lgkmcnt(0)
    s_barrier
    v_and_b32 v55, 1, v52
    v_xor_b32 v55, 1, v55
    v_mul_u32_u24 v55, 4576, v55
    v_lshrrev_b32 v90, 1, v52
    v_lshlrev_b32 v90, 6, v90
    v_lshl_add_u32 v90, v53, 4, v90
    v_add3_u32 v3, v55, v90, s37
    v_add_u32 v3, 8832, v3
    v_mov_b32 v4, v3
    v_and_b32 v55, 1, v52
    v_mul_u32_u24 v55, 4220, v55
    v_lshlrev_b32 v90, 2, v52
    v_sub_u32 v55, v55, v90
    v_lshl_add_u32 v55, v53, 4, v55
    v_add_u32 v55, 512, v55
    v_add_u32 v5, s37, v55
    v_mov_b32 v12, 0
    v_mov_b32 v13, 0
    v_mov_b32 v14, 0
    v_mov_b32 v15, 0
    v_mov_b32 v16, 0
    v_mov_b32 v17, 0
    v_mov_b32 v18, 0
    v_mov_b32 v19, 0
    v_mov_b32 v20, 0
    v_mov_b32 v21, 0
    v_mov_b32 v22, 0
    v_mov_b32 v23, 0
    v_mov_b32 v24, 0
    v_mov_b32 v25, 0
    v_mov_b32 v26, 0
    v_mov_b32 v27, 0
    v_mov_b32 v28, 0
    v_mov_b32 v29, 0
    v_mov_b32 v30, 0
    v_mov_b32 v31, 0
    v_mov_b32 v32, 0
    v_mov_b32 v33, 0
    v_mov_b32 v34, 0
    v_mov_b32 v35, 0
    v_mov_b32 v36, 0
    v_mov_b32 v37, 0
    v_mov_b32 v38, 0
    v_mov_b32 v39, 0
    v_mov_b32 v40, 0
    v_mov_b32 v41, 0
    v_mov_b32 v42, 0
    v_mov_b32 v43, 0
    ds_read_b64 v[56:57], v5 offset:3584
    ds_read_b64 v[58:59], v5 offset:3592
    ds_read_b128 v[124:127], v3 offset:3584
    ds_read_b64 v[60:61], v5 offset:3072
    ds_read_b64 v[62:63], v5 offset:3080
    ds_read_b128 v[120:123], v3 offset:3072
    ds_read_b64 v[64:65], v5 offset:2560
    ds_read_b64 v[66:67], v5 offset:2568
    ds_read_b128 v[116:119], v3 offset:2560
    ds_read_b64 v[68:69], v5 offset:2048
    ds_read_b64 v[70:71], v5 offset:2056
    ds_read_b128 v[112:115], v3 offset:2048
    ds_read_b64 v[72:73], v5 offset:1536
    ds_read_b64 v[74:75], v5 offset:1544
    ds_read_b128 v[108:111], v3 offset:1536
    ds_read_b64 v[76:77], v5 offset:1024
    ds_read_b64 v[78:79], v5 offset:1032
    ds_read_b128 v[104:107], v3 offset:1024
    ds_read_b64 v[80:81], v5 offset:512
    ds_read_b64 v[82:83], v5 offset:520
    ds_read_b128 v[100:103], v3 offset:512
    ds_read_b64 v[84:85], v5 offset:0
    ds_read_b64 v[86:87], v5 offset:8
    ds_read_b128 v[96:99], v3 offset:0
    s_mov_b32 s56, 0
L_conv:
    v_subrev_u32 v3, 64, v3
    v_subrev_u32 v5, 64, v5
    s_waitcnt lgkmcnt(9)
    v_mfma_f32_16x16x32_bf16 v[40:43], v[56:59], v[124:127], v[40:43]
    v_mfma_f32_16x16x32_bf16 v[36:39], v[56:59], v[120:123], v[36:39]
    v_mfma_f32_16x16x32_bf16 v[32:35], v[56:59], v[116:119], v[32:35]
    v_mfma_f32_16x16x32_bf16 v[28:31], v[56:59], v[112:115], v[28:31]
    v_mfma_f32_16x16x32_bf16 v[24:27], v[56:59], v[108:111], v[24:27]
    s_waitcnt lgkmcnt(0)
    v_mfma_f32_16x16x32_bf16 v[20:23], v[56:59], v[104:107], v[20:23]
    v_mfma_f32_16x16x32_bf16 v[16:19], v[56:59], v[100:103], v[16:19]
    v_mfma_f32_16x16x32_bf16 v[12:15], v[56:59], v[96:99], v[12:15]
    ds_read_b64 v[56:57], v5 offset:3584
    ds_read_b64 v[58:59], v5 offset:3592
    ds_read_b128 v[124:127], v3 offset:3584
    v_mfma_f32_16x16x32_bf16 v[40:43], v[60:63], v[120:123], v[40:43]
    v_mfma_f32_16x16x32_bf16 v[36:39], v[60:63], v[116:119], v[36:39]
    v_mfma_f32_16x16x32_bf16 v[32:35], v[60:63], v[112:115], v[32:35]
    v_mfma_f32_16x16x32_bf16 v[28:31], v[60:63], v[108:111], v[28:31]
    v_mfma_f32_16x16x32_bf16 v[24:27], v[60:63], v[104:107], v[24:27]
    v_mfma_f32_16x16x32_bf16 v[20:23], v[60:63], v[100:103], v[20:23]
    v_mfma_f32_16x16x32_bf16 v[16:19], v[60:63], v[96:99], v[16:19]
    ds_read_b64 v[60:61], v5 offset:3072
    ds_read_b64 v[62:63], v5 offset:3080
    ds_read_b128 v[120:123], v3 offset:3072
    v_mfma_f32_16x16x32_bf16 v[40:43], v[64:67], v[116:119], v[40:43]
    v_mfma_f32_16x16x32_bf16 v[36:39], v[64:67], v[112:115], v[36:39]
    v_mfma_f32_16x16x32_bf16 v[32:35], v[64:67], v[108:111], v[32:35]
    v_mfma_f32_16x16x32_bf16 v[28:31], v[64:67], v[104:107], v[28:31]
    v_mfma_f32_16x16x32_bf16 v[24:27], v[64:67], v[100:103], v[24:27]
    v_mfma_f32_16x16x32_bf16 v[20:23], v[64:67], v[96:99], v[20:23]
    ds_read_b64 v[64:65], v5 offset:2560
    ds_read_b64 v[66:67], v5 offset:2568
    ds_read_b128 v[116:119], v3 offset:2560
    v_mfma_f32_16x16x32_bf16 v[40:43], v[68:71], v[112:115], v[40:43]
    v_mfma_f32_16x16x32_bf16 v[36:39], v[68:71], v[108:111], v[36:39]
    v_mfma_f32_16x16x32_bf16 v[32:35], v[68:71], v[104:107], v[32:35]
    v_mfma_f32_16x16x32_bf16 v[28:31], v[68:71], v[100:103], v[28:31]
    v_mfma_f32_16x16x32_bf16 v[24:27], v[68:71], v[96:99], v[24:27]
    ds_read_b64 v[68:69], v5 offset:2048
    ds_read_b64 v[70:71], v5 offset:2056
    ds_read_b128 v[112:115], v3 offset:2048
    v_mfma_f32_16x16x32_bf16 v[40:43], v[72:75], v[108:111], v[40:43]
    v_mfma_f32_16x16x32_bf16 v[36:39], v[72:75], v[104:107], v[36:39]
    v_mfma_f32_16x16x32_bf16 v[32:35], v[72:75], v[100:103], v[32:35]
    v_mfma_f32_16x16x32_bf16 v[28:31], v[72:75], v[96:99], v[28:31]
    ds_read_b64 v[72:73], v5 offset:1536
    ds_read_b64 v[74:75], v5 offset:1544
    ds_read_b128 v[108:111], v3 offset:1536
    v_mfma_f32_16x16x32_bf16 v[40:43], v[76:79], v[104:107], v[40:43]
    v_mfma_f32_16x16x32_bf16 v[36:39], v[76:79], v[100:103], v[36:39]
    v_mfma_f32_16x16x32_bf16 v[32:35], v[76:79], v[96:99], v[32:35]
    ds_read_b64 v[76:77], v5 offset:1024
    ds_read_b64 v[78:79], v5 offset:1032
    ds_read_b128 v[104:107], v3 offset:1024
    v_mfma_f32_16x16x32_bf16 v[40:43], v[80:83], v[100:103], v[40:43]
    v_mfma_f32_16x16x32_bf16 v[36:39], v[80:83], v[96:99], v[36:39]
    ds_read_b64 v[80:81], v5 offset:512
    ds_read_b64 v[82:83], v5 offset:520
    ds_read_b128 v[100:103], v3 offset:512
    v_mfma_f32_16x16x32_bf16 v[40:43], v[84:87], v[96:99], v[40:43]
    ds_read_b64 v[84:85], v5 offset:0
    ds_read_b64 v[86:87], v5 offset:8
    ds_read_b128 v[96:99], v3 offset:0
    s_add_u32 s56, s56, 1
    s_cmp_lt_u32 s56, 8
    s_cbranch_scc1 L_conv
    s_waitcnt lgkmcnt(0)
    ds_read_b128 v[96:99], v4 offset:0
    ds_read_b128 v[100:103], v4 offset:512
    ds_read_b128 v[104:107], v4 offset:1024
    ds_read_b128 v[108:111], v4 offset:1536
    ds_read_b128 v[112:115], v4 offset:2048
    ds_read_b128 v[116:119], v4 offset:2560
    ds_read_b128 v[120:123], v4 offset:3072
    ds_read_b128 v[124:127], v4 offset:3584
    s_mov_b32 s57, 0xffff0000
    v_and_b32 v55, 1, v52
    v_cmp_eq_u32 vcc, 0, v55
    v_mov_b32 v90, 0x05040100
    v_mov_b32 v91, 0x01000504
    v_cndmask_b32 v6, v91, v90, vcc
    v_mov_b32 v90, 0x07060302
    v_mov_b32 v91, 0x03020706
    v_cndmask_b32 v7, v91, v90, vcc
    v_lshrrev_b32 v90, 1, v52
    v_lshlrev_b32 v90, 6, v90
    v_lshl_add_u32 v90, v53, 4, v90
    v_lshl_add_u32 v90, v55, 3, v90
    v_add_u32 v9, s37, v90
    s_waitcnt lgkmcnt(0)
    v_and_b32 v96, s57, v96
    v_and_b32 v97, s57, v97
    v_and_b32 v98, s57, v98
    v_and_b32 v99, s57, v99
    v_fma_f32 v12, v96, v8, v12
    v_fma_f32 v13, v97, v8, v13
    v_fma_f32 v14, v98, v8, v14
    v_fma_f32 v15, v99, v8, v15
    v_cvt_pk_bf16_f32 v56, v12, v13
    v_cvt_pk_bf16_f32 v57, v14, v15
    v_cndmask_b32 v58, v57, v56, vcc
    v_cndmask_b32 v59, v56, v57, vcc
    s_nop 1
    v_mov_b32_dpp v56, v59 quad_perm:[1,0,3,2] row_mask:0xf bank_mask:0xf
    v_perm_b32 v12, v56, v58, v6
    v_perm_b32 v13, v56, v58, v7
    ds_write_b64 v9, v[12:13] offset:0
    v_and_b32 v100, s57, v100
    v_and_b32 v101, s57, v101
    v_and_b32 v102, s57, v102
    v_and_b32 v103, s57, v103
    v_fma_f32 v16, v100, v8, v16
    v_fma_f32 v17, v101, v8, v17
    v_fma_f32 v18, v102, v8, v18
    v_fma_f32 v19, v103, v8, v19
    v_cvt_pk_bf16_f32 v60, v16, v17
    v_cvt_pk_bf16_f32 v61, v18, v19
    v_cndmask_b32 v62, v61, v60, vcc
    v_cndmask_b32 v63, v60, v61, vcc
    s_nop 1
    v_mov_b32_dpp v60, v63 quad_perm:[1,0,3,2] row_mask:0xf bank_mask:0xf
    v_perm_b32 v16, v60, v62, v6
    v_perm_b32 v17, v60, v62, v7
    ds_write_b64 v9, v[16:17] offset:512
    v_and_b32 v104, s57, v104
    v_and_b32 v105, s57, v105
    v_and_b32 v106, s57, v106
    v_and_b32 v107, s57, v107
    v_fma_f32 v20, v104, v8, v20
    v_fma_f32 v21, v105, v8, v21
    v_fma_f32 v22, v106, v8, v22
    v_fma_f32 v23, v107, v8, v23
    v_cvt_pk_bf16_f32 v64, v20, v21
    v_cvt_pk_bf16_f32 v65, v22, v23
    v_cndmask_b32 v66, v65, v64, vcc
    v_cndmask_b32 v67, v64, v65, vcc
    s_nop 1
    v_mov_b32_dpp v64, v67 quad_perm:[1,0,3,2] row_mask:0xf bank_mask:0xf
    v_perm_b32 v20, v64, v66, v6
    v_perm_b32 v21, v64, v66, v7
    ds_write_b64 v9, v[20:21] offset:1024
    v_and_b32 v108, s57, v108
    v_and_b32 v109, s57, v109
    v_and_b32 v110, s57, v110
    v_and_b32 v111, s57, v111
    v_fma_f32 v24, v108, v8, v24
    v_fma_f32 v25, v109, v8, v25
    v_fma_f32 v26, v110, v8, v26
    v_fma_f32 v27, v111, v8, v27
    v_cvt_pk_bf16_f32 v68, v24, v25
    v_cvt_pk_bf16_f32 v69, v26, v27
    v_cndmask_b32 v70, v69, v68, vcc
    v_cndmask_b32 v71, v68, v69, vcc
    s_nop 1
    v_mov_b32_dpp v68, v71 quad_perm:[1,0,3,2] row_mask:0xf bank_mask:0xf
    v_perm_b32 v24, v68, v70, v6
    v_perm_b32 v25, v68, v70, v7
    ds_write_b64 v9, v[24:25] offset:1536
    v_and_b32 v112, s57, v112
    v_and_b32 v113, s57, v113
    v_and_b32 v114, s57, v114
    v_and_b32 v115, s57, v115
    v_fma_f32 v28, v112, v8, v28
    v_fma_f32 v29, v113, v8, v29
    v_fma_f32 v30, v114, v8, v30
    v_fma_f32 v31, v115, v8, v31
    v_cvt_pk_bf16_f32 v72, v28, v29
    v_cvt_pk_bf16_f32 v73, v30, v31
    v_cndmask_b32 v74, v73, v72, vcc
    v_cndmask_b32 v75, v72, v73, vcc
    s_nop 1
    v_mov_b32_dpp v72, v75 quad_perm:[1,0,3,2] row_mask:0xf bank_mask:0xf
    v_perm_b32 v28, v72, v74, v6
    v_perm_b32 v29, v72, v74, v7
    ds_write_b64 v9, v[28:29] offset:2048
    v_and_b32 v116, s57, v116
    v_and_b32 v117, s57, v117
    v_and_b32 v118, s57, v118
    v_and_b32 v119, s57, v119
    v_fma_f32 v32, v116, v8, v32
    v_fma_f32 v33, v117, v8, v33
    v_fma_f32 v34, v118, v8, v34
    v_fma_f32 v35, v119, v8, v35
    v_cvt_pk_bf16_f32 v76, v32, v33
    v_cvt_pk_bf16_f32 v77, v34, v35
    v_cndmask_b32 v78, v77, v76, vcc
    v_cndmask_b32 v79, v76, v77, vcc
    s_nop 1
    v_mov_b32_dpp v76, v79 quad_perm:[1,0,3,2] row_mask:0xf bank_mask:0xf
    v_perm_b32 v32, v76, v78, v6
    v_perm_b32 v33, v76, v78, v7
    ds_write_b64 v9, v[32:33] offset:2560
    v_and_b32 v120, s57, v120
    v_and_b32 v121, s57, v121
    v_and_b32 v122, s57, v122
    v_and_b32 v123, s57, v123
    v_fma_f32 v36, v120, v8, v36
    v_fma_f32 v37, v121, v8, v37
    v_fma_f32 v38, v122, v8, v38
    v_fma_f32 v39, v123, v8, v39
    v_cvt_pk_bf16_f32 v80, v36, v37
    v_cvt_pk_bf16_f32 v81, v38, v39
    v_cndmask_b32 v82, v81, v80, vcc
    v_cndmask_b32 v83, v80, v81, vcc
    s_nop 1
    v_mov_b32_dpp v80, v83 quad_perm:[1,0,3,2] row_mask:0xf bank_mask:0xf
    v_perm_b32 v36, v80, v82, v6
    v_perm_b32 v37, v80, v82, v7
    ds_write_b64 v9, v[36:37] offset:3072
    v_and_b32 v124, s57, v124
    v_and_b32 v125, s57, v125
    v_and_b32 v126, s57, v126
    v_and_b32 v127, s57, v127
    v_fma_f32 v40, v124, v8, v40
    v_fma_f32 v41, v125, v8, v41
    v_fma_f32 v42, v126, v8, v42
    v_fma_f32 v43, v127, v8, v43
    v_cvt_pk_bf16_f32 v84, v40, v41
    v_cvt_pk_bf16_f32 v85, v42, v43
    v_cndmask_b32 v86, v85, v84, vcc
    v_cndmask_b32 v87, v84, v85, vcc
    s_nop 1
    v_mov_b32_dpp v84, v87 quad_perm:[1,0,3,2] row_mask:0xf bank_mask:0xf
    v_perm_b32 v40, v84, v86, v6
    v_perm_b32 v41, v84, v86, v7
    ds_write_b64 v9, v[40:41] offset:3584
    s_waitcnt lgkmcnt(0)
    s_barrier
    v_lshrrev_b32 v55, 2, v52
    v_mul_u32_u24 v55, 20416, v55
    v_and_b32 v90, 3, v52
    v_lshlrev_b32 v90, 3, v90
    v_lshl_add_u32 v90, v53, 5, v90
    s_lshl_b32 s52, s35, 9
    v_add3_u32 v10, v55, v90, s52
    v_add_u32 v11, 81664, v10
    s_lshl_b32 s52, s35, 8
    v_add_u32 v44, s52, v1
    v_mul_u32_u24 v44, 2560, v44
    s_lshl_b32 s52, s34, 4
    v_add_u32 v44, s52, v44
    ds_read_b64_tr_b16 v[56:57], v10 offset:0
    ds_read_b64_tr_b16 v[58:59], v11 offset:0
    ds_read_b64_tr_b16 v[60:61], v10 offset:128
    ds_read_b64_tr_b16 v[62:63], v11 offset:128
    ds_read_b64_tr_b16 v[64:65], v10 offset:256
    ds_read_b64_tr_b16 v[66:67], v11 offset:256
    ds_read_b64_tr_b16 v[68:69], v10 offset:384
    ds_read_b64_tr_b16 v[70:71], v11 offset:384
    s_waitcnt lgkmcnt(6)
    s_mov_b32 s52, 0
    buffer_store_dwordx4 v[56:59], v44, s[48:51], s52 offen
    s_waitcnt lgkmcnt(4)
    s_mov_b32 s52, 163840
    buffer_store_dwordx4 v[60:63], v44, s[48:51], s52 offen
    s_waitcnt lgkmcnt(2)
    s_mov_b32 s52, 327680
    buffer_store_dwordx4 v[64:67], v44, s[48:51], s52 offen
    s_waitcnt lgkmcnt(0)
    s_mov_b32 s52, 491520
    buffer_store_dwordx4 v[68:71], v44, s[48:51], s52 offen
    s_endpgm
L_partb:
    s_and_b32 s32, s2, 7
    s_lshr_b32 s33, s2, 3
    s_lshr_b32 s60, s32, 2
    s_mul_i32 s60, s60, 22
    s_add_u32 s34, s60, s33
    s_lshr_b32 s35, s34, 2
    s_and_b32 s60, s34, 3
    s_and_b32 s61, s32, 3
    s_lshl_b32 s61, s61, 2
    s_add_u32 s36, s61, s60
    s_mul_i32 s87, s35, 192
    s_xor_b32 s80, s36, 0
    s_mul_i32 s61, s60, 3
    s_lshl_b32 s62, s35, 1
    s_add_u32 s81, s61, s62
    s_mul_i32 s61, s81, 205
    s_lshr_b32 s61, s61, 11
    s_mul_i32 s61, s61, 10
    s_sub_u32 s81, s81, s61
    v_lshrrev_b32 v4, 6, v0
    v_and_b32 v1, 63, v0
    v_readfirstlane_b32 s37, v4
    v_and_b32 v2, 15, v1
    v_lshrrev_b32 v3, 4, v1
    s_nop 1
    s_and_b32 s38, s37, 3
    s_lshr_b32 s39, s37, 2
    s_cmp_eq_u32 s39, 2
    s_cbranch_scc0 L_b_compute
    s_mul_i32 s60, s38, 48
    s_add_u32 s60, s60, s87
    v_lshrrev_b32 v4, 3, v1
    v_add_u32 v4, s60, v4
    v_mul_u32_u24 v4, 1280, v4
    v_and_b32 v5, 7, v1
    v_xor_b32 v6, v5, v3
    v_lshl_add_u32 v8, v6, 4, v4
    v_xor_b32 v6, 4, v6
    v_lshl_add_u32 v9, v6, 4, v4
    v_lshlrev_b32 v4, 1, v3
    v_add_u32 v4, 0, v4
    v_xor_b32 v4, v4, v2
    v_min_u32 v4, 14, v4
    v_lshlrev_b32 v5, 4, v4
    v_add_u32 v6, 2400, v5
    s_sub_u32 s61, s80, s36
    s_mul_i32 s61, s61, 80
    s_sub_u32 s61, s61, 128
    v_add_u32 v7, s61, v5
    v_cmp_gt_u32 vcc, 13, v4
    s_nop 1
    v_cndmask_b32 v6, v6, v7, vcc
    v_add_u32 v7, 2480, v5
    v_cmp_gt_u32 vcc, 8, v4
    s_nop 1
    v_cndmask_b32 v6, v6, v7, vcc
    v_add_u32 v7, 1280, v5
    v_cmp_gt_u32 vcc, 5, v4
    s_nop 1
    v_cndmask_b32 v6, v6, v7, vcc
    s_mul_i32 s60, s36, 80
    s_mul_i32 s61, s38, 61440
    s_add_u32 s60, s60, s61
    v_mul_u32_u24 v4, 3840, v3
    v_add3_u32 v10, v4, v6, s60
    v_lshlrev_b32 v4, 1, v3
    v_add_u32 v4, 8, v4
    v_xor_b32 v4, v4, v2
    v_min_u32 v4, 14, v4
    v_lshlrev_b32 v5, 4, v4
    v_add_u32 v6, 2400, v5
    s_sub_u32 s61, s80, s36
    s_mul_i32 s61, s61, 80
    s_sub_u32 s61, s61, 128
    v_add_u32 v7, s61, v5
    v_cmp_gt_u32 vcc, 13, v4
    s_nop 1
    v_cndmask_b32 v6, v6, v7, vcc
    v_add_u32 v7, 2480, v5
    v_cmp_gt_u32 vcc, 8, v4
    s_nop 1
    v_cndmask_b32 v6, v6, v7, vcc
    v_add_u32 v7, 1280, v5
    v_cmp_gt_u32 vcc, 5, v4
    s_nop 1
    v_cndmask_b32 v6, v6, v7, vcc
    s_mul_i32 s60, s36, 80
    s_mul_i32 s61, s38, 61440
    s_add_u32 s60, s60, s61
    v_mul_u32_u24 v4, 3840, v3
    v_add3_u32 v11, v4, v6, s60
    s_mul_i32 s90, s38, 6144
    s_lshl_b32 s91, s38, 12
    s_add_u32 s91, s91, 24576
    s_mov_b32 s94, 0
    s_waitcnt lgkmcnt(0)
    s_mov_b32 s40, s18
    s_and_b32 s41, s19, 0xffff
    s_mov_b32 s42, 2621440
    s_mov_b32 s43, 0x00020000
    s_mov_b32 s44, s20
    s_and_b32 s45, s21, 0xffff
    s_mov_b32 s46, 2457600
    s_mov_b32 s47, 0x00020000
    s_mov_b32 s82, 0
L_p_pro:
    s_lshl_b32 s84, s81, 7
    s_mul_i32 s85, s81, 245760
    s_add_u32 s86, s90, s94
    s_add_u32 s62, s91, s94
    s_add_u32 s60, s84, 0
    s_add_u32 m0, s86, 0
    s_nop 0
    buffer_load_dwordx4 v8, s[40:43], s60 offen lds
    s_add_u32 s60, s85, 0
    s_add_u32 m0, s62, 0
    s_nop 0
    buffer_load_dwordx4 v10, s[44:47], s60 offen lds
    s_add_u32 s60, s84, 10240
    s_add_u32 m0, s86, 1024
    s_nop 0
    buffer_load_dwordx4 v9, s[40:43], s60 offen lds
    s_add_u32 s60, s84, 20480
    s_add_u32 m0, s86, 2048
    s_nop 0
    buffer_load_dwordx4 v8, s[40:43], s60 offen lds
    s_add_u32 s60, s85, 15360
    s_add_u32 m0, s62, 1024
    s_nop 0
    buffer_load_dwordx4 v10, s[44:47], s60 offen lds
    s_add_u32 s60, s84, 30720
    s_add_u32 m0, s86, 3072
    s_nop 0
    buffer_load_dwordx4 v9, s[40:43], s60 offen lds
    s_add_u32 s60, s85, 30720
    s_add_u32 m0, s62, 2048
    s_nop 0
    buffer_load_dwordx4 v11, s[44:47], s60 offen lds
    s_add_u32 s60, s84, 40960
    s_add_u32 m0, s86, 4096
    s_nop 0
    buffer_load_dwordx4 v8, s[40:43], s60 offen lds
    s_add_u32 s60, s84, 51200
    s_add_u32 m0, s86, 5120
    s_nop 0
    buffer_load_dwordx4 v9, s[40:43], s60 offen lds
    s_add_u32 s60, s85, 46080
    s_add_u32 m0, s62, 3072
    s_nop 0
    buffer_load_dwordx4 v11, s[44:47], s60 offen lds
    s_add_u32 s81, s81, 1
    s_cmp_eq_u32 s81, 10
    s_cselect_b32 s81, 0, s81
    s_add_u32 s94, s94, 40960
    s_cmp_eq_u32 s94, 163840
    s_cselect_b32 s94, 0, s94
    s_add_u32 s82, s82, 1
    s_cmp_lt_u32 s82, 3
    s_cbranch_scc1 L_p_pro
    s_mov_b32 s48, s30
    s_and_b32 s49, s31, 0xffff
    s_mov_b32 s50, 16777216
    s_mov_b32 s51, 0x00020000
    s_mov_b32 s52, s24
    s_and_b32 s53, s25, 0xffff
    s_mov_b32 s54, 819200
    s_mov_b32 s55, 0x00020000
    s_waitcnt vmcnt(20)
    s_barrier
    v_mov_b32 v12, -1
    v_mov_b32 v13, -1
    v_mov_b32 v14, -1
    v_mov_b32 v15, -1
    s_lshl_b32 s60, s35, 4
    s_add_u32 s60, s60, s36
    s_mul_i32 s60, s60, 5120
    s_mul_i32 s61, s38, 1280
    s_add_u32 s60, s60, s61
    s_add_u32 s60, s60, 65536
    v_lshl_add_u32 v16, v1, 4, s60
    s_add_u32 s60, s60, 1024
    v_lshl_add_u32 v17, v1, 2, s60
    buffer_store_dwordx4 v[12:15], v16, s[48:51], 0 offen sc1
    buffer_store_dword v12, v17, s[48:51], 0 offen sc1
    s_lshl_b32 s84, s81, 7
    s_mul_i32 s85, s81, 245760
    s_add_u32 s86, s90, s94
    s_add_u32 s62, s91, s94
    s_add_u32 s60, s84, 0
    s_add_u32 m0, s86, 0
    s_nop 0
    buffer_load_dwordx4 v8, s[40:43], s60 offen lds
    s_add_u32 s60, s85, 0
    s_add_u32 m0, s62, 0
    s_nop 0
    buffer_load_dwordx4 v10, s[44:47], s60 offen lds
    s_add_u32 s60, s84, 10240
    s_add_u32 m0, s86, 1024
    s_nop 0
    buffer_load_dwordx4 v9, s[40:43], s60 offen lds
    s_add_u32 s60, s84, 20480
    s_add_u32 m0, s86, 2048
    s_nop 0
    buffer_load_dwordx4 v8, s[40:43], s60 offen lds
    s_add_u32 s60, s85, 15360
    s_add_u32 m0, s62, 1024
    s_nop 0
    buffer_load_dwordx4 v10, s[44:47], s60 offen lds
    s_add_u32 s60, s84, 30720
    s_add_u32 m0, s86, 3072
    s_nop 0
    buffer_load_dwordx4 v9, s[40:43], s60 offen lds
    s_add_u32 s60, s85, 30720
    s_add_u32 m0, s62, 2048
    s_nop 0
    buffer_load_dwordx4 v11, s[44:47], s60 offen lds
    s_add_u32 s60, s84, 40960
    s_add_u32 m0, s86, 4096
    s_nop 0
    buffer_load_dwordx4 v8, s[40:43], s60 offen lds
    s_add_u32 s60, s84, 51200
    s_add_u32 m0, s86, 5120
    s_nop 0
    buffer_load_dwordx4 v9, s[40:43], s60 offen lds
    s_add_u32 s60, s85, 46080
    s_add_u32 m0, s62, 3072
    s_nop 0
    buffer_load_dwordx4 v11, s[44:47], s60 offen lds
    s_add_u32 s81, s81, 1
    s_cmp_eq_u32 s81, 10
    s_cselect_b32 s81, 0, s81
    s_add_u32 s94, s94, 40960
    s_cmp_eq_u32 s94, 163840
    s_cselect_b32 s94, 0, s94
    s_waitcnt vmcnt(22)
    s_barrier
    s_lshl_b32 s84, s81, 7
    s_mul_i32 s85, s81, 245760
    s_add_u32 s86, s90, s94
    s_add_u32 s62, s91, s94
    s_add_u32 s60, s84, 0
    s_add_u32 m0, s86, 0
    s_nop 0
    buffer_load_dwordx4 v8, s[40:43], s60 offen lds
    s_add_u32 s60, s85, 0
    s_add_u32 m0, s62, 0
    s_nop 0
    buffer_load_dwordx4 v10, s[44:47], s60 offen lds
    s_add_u32 s60, s84, 10240
    s_add_u32 m0, s86, 1024
    s_nop 0
    buffer_load_dwordx4 v9, s[40:43], s60 offen lds
    s_add_u32 s60, s84, 20480
    s_add_u32 m0, s86, 2048
    s_nop 0
    buffer_load_dwordx4 v8, s[40:43], s60 offen lds
    s_add_u32 s60, s85, 15360
    s_add_u32 m0, s62, 1024
    s_nop 0
    buffer_load_dwordx4 v10, s[44:47], s60 offen lds
    s_add_u32 s60, s84, 30720
    s_add_u32 m0, s86, 3072
    s_nop 0
    buffer_load_dwordx4 v9, s[40:43], s60 offen lds
    s_add_u32 s60, s85, 30720
    s_add_u32 m0, s62, 2048
    s_nop 0
    buffer_load_dwordx4 v11, s[44:47], s60 offen lds
    s_add_u32 s60, s84, 40960
    s_add_u32 m0, s86, 4096
    s_nop 0
    buffer_load_dwordx4 v8, s[40:43], s60 offen lds
    s_add_u32 s60, s84, 51200
    s_add_u32 m0, s86, 5120
    s_nop 0
    buffer_load_dwordx4 v9, s[40:43], s60 offen lds
    s_add_u32 s60, s85, 46080
    s_add_u32 m0, s62, 3072
    s_nop 0
    buffer_load_dwordx4 v11, s[44:47], s60 offen lds
    s_add_u32 s81, s81, 1
    s_cmp_eq_u32 s81, 10
    s_cselect_b32 s81, 0, s81
    s_add_u32 s94, s94, 40960
    s_cmp_eq_u32 s94, 163840
    s_cselect_b32 s94, 0, s94
    s_waitcnt vmcnt(22)
    s_barrier
    s_lshl_b32 s84, s81, 7
    s_mul_i32 s85, s81, 245760
    s_add_u32 s86, s90, s94
    s_add_u32 s62, s91, s94
    s_add_u32 s60, s84, 0
    s_add_u32 m0, s86, 0
    s_nop 0
    buffer_load_dwordx4 v8, s[40:43], s60 offen lds
    s_add_u32 s60, s85, 0
    s_add_u32 m0, s62, 0
    s_nop 0
    buffer_load_dwordx4 v10, s[44:47], s60 offen lds
    s_add_u32 s60, s84, 10240
    s_add_u32 m0, s86, 1024
    s_nop 0
    buffer_load_dwordx4 v9, s[40:43], s60 offen lds
    s_add_u32 s60, s84, 20480
    s_add_u32 m0, s86, 2048
    s_nop 0
    buffer_load_dwordx4 v8, s[40:43], s60 offen lds
    s_add_u32 s60, s85, 15360
    s_add_u32 m0, s62, 1024
    s_nop 0
    buffer_load_dwordx4 v10, s[44:47], s60 offen lds
    s_add_u32 s60, s84, 30720
    s_add_u32 m0, s86, 3072
    s_nop 0
    buffer_load_dwordx4 v9, s[40:43], s60 offen lds
    s_add_u32 s60, s85, 30720
    s_add_u32 m0, s62, 2048
    s_nop 0
    buffer_load_dwordx4 v11, s[44:47], s60 offen lds
    s_add_u32 s60, s84, 40960
    s_add_u32 m0, s86, 4096
    s_nop 0
    buffer_load_dwordx4 v8, s[40:43], s60 offen lds
    s_add_u32 s60, s84, 51200
    s_add_u32 m0, s86, 5120
    s_nop 0
    buffer_load_dwordx4 v9, s[40:43], s60 offen lds
    s_add_u32 s60, s85, 46080
    s_add_u32 m0, s62, 3072
    s_nop 0
    buffer_load_dwordx4 v11, s[44:47], s60 offen lds
    s_add_u32 s81, s81, 1
    s_cmp_eq_u32 s81, 10
    s_cselect_b32 s81, 0, s81
    s_add_u32 s94, s94, 40960
    s_cmp_eq_u32 s94, 163840
    s_cselect_b32 s94, 0, s94
    s_waitcnt vmcnt(20)
    s_barrier
    s_cmp_lg_u32 s38, 0
    s_cbranch_scc1 L_p_nocntp
    v_mov_b32 v4, 4
    v_mov_b32 v5, 1
    s_mov_b32 exec_lo, 1
    s_mov_b32 exec_hi, 0
    global_atomic_add v4, v5, s[28:29] sc1
    s_mov_b64 exec, -1
L_p_nocntp:
    s_lshl_b32 s84, s81, 7
    s_mul_i32 s85, s81, 245760
    s_add_u32 s86, s90, s94
    s_add_u32 s62, s91, s94
    s_add_u32 s60, s84, 0
    s_add_u32 m0, s86, 0
    s_nop 0
    buffer_load_dwordx4 v8, s[40:43], s60 offen lds
    s_add_u32 s60, s85, 0
    s_add_u32 m0, s62, 0
    s_nop 0
    buffer_load_dwordx4 v10, s[44:47], s60 offen lds
    s_add_u32 s60, s84, 10240
    s_add_u32 m0, s86, 1024
    s_nop 0
    buffer_load_dwordx4 v9, s[40:43], s60 offen lds
    s_add_u32 s60, s84, 20480
    s_add_u32 m0, s86, 2048
    s_nop 0
    buffer_load_dwordx4 v8, s[40:43], s60 offen lds
    s_add_u32 s60, s85, 15360
    s_add_u32 m0, s62, 1024
    s_nop 0
    buffer_load_dwordx4 v10, s[44:47], s60 offen lds
    s_add_u32 s60, s84, 30720
    s_add_u32 m0, s86, 3072
    s_nop 0
    buffer_load_dwordx4 v9, s[40:43], s60 offen lds
    s_add_u32 s60, s85, 30720
    s_add_u32 m0, s62, 2048
    s_nop 0
    buffer_load_dwordx4 v11, s[44:47], s60 offen lds
    s_add_u32 s60, s84, 40960
    s_add_u32 m0, s86, 4096
    s_nop 0
    buffer_load_dwordx4 v8, s[40:43], s60 offen lds
    s_add_u32 s60, s84, 51200
    s_add_u32 m0, s86, 5120
    s_nop 0
    buffer_load_dwordx4 v9, s[40:43], s60 offen lds
    s_add_u32 s60, s85, 46080
    s_add_u32 m0, s62, 3072
    s_nop 0
    buffer_load_dwordx4 v11, s[44:47], s60 offen lds
    s_add_u32 s81, s81, 1
    s_cmp_eq_u32 s81, 10
    s_cselect_b32 s81, 0, s81
    s_add_u32 s94, s94, 40960
    s_cmp_eq_u32 s94, 163840
    s_cselect_b32 s94, 0, s94
    s_waitcnt vmcnt(20)
    s_barrier
    s_lshl_b32 s84, s81, 7
    s_mul_i32 s85, s81, 245760
    s_add_u32 s86, s90, s94
    s_add_u32 s62, s91, s94
    s_add_u32 s60, s84, 0
    s_add_u32 m0, s86, 0
    s_nop 0
    buffer_load_dwordx4 v8, s[40:43], s60 offen lds
    s_add_u32 s60, s85, 0
    s_add_u32 m0, s62, 0
    s_nop 0
    buffer_load_dwordx4 v10, s[44:47], s60 offen lds
    s_add_u32 s60, s84, 10240
    s_add_u32 m0, s86, 1024
    s_nop 0
    buffer_load_dwordx4 v9, s[40:43], s60 offen lds
    s_add_u32 s60, s84, 20480
    s_add_u32 m0, s86, 2048
    s_nop 0
    buffer_load_dwordx4 v8, s[40:43], s60 offen lds
    s_add_u32 s60, s85, 15360
    s_add_u32 m0, s62, 1024
    s_nop 0
    buffer_load_dwordx4 v10, s[44:47], s60 offen lds
    s_add_u32 s60, s84, 30720
    s_add_u32 m0, s86, 3072
    s_nop 0
    buffer_load_dwordx4 v9, s[40:43], s60 offen lds
    s_add_u32 s60, s85, 30720
    s_add_u32 m0, s62, 2048
    s_nop 0
    buffer_load_dwordx4 v11, s[44:47], s60 offen lds
    s_add_u32 s60, s84, 40960
    s_add_u32 m0, s86, 4096
    s_nop 0
    buffer_load_dwordx4 v8, s[40:43], s60 offen lds
    s_add_u32 s60, s84, 51200
    s_add_u32 m0, s86, 5120
    s_nop 0
    buffer_load_dwordx4 v9, s[40:43], s60 offen lds
    s_add_u32 s60, s85, 46080
    s_add_u32 m0, s62, 3072
    s_nop 0
    buffer_load_dwordx4 v11, s[44:47], s60 offen lds
    s_add_u32 s81, s81, 1
    s_cmp_eq_u32 s81, 10
    s_cselect_b32 s81, 0, s81
    s_add_u32 s94, s94, 40960
    s_cmp_eq_u32 s94, 163840
    s_cselect_b32 s94, 0, s94
    s_waitcnt vmcnt(20)
    s_barrier
    s_lshl_b32 s84, s81, 7
    s_mul_i32 s85, s81, 245760
    s_add_u32 s86, s90, s94
    s_add_u32 s62, s91, s94
    s_add_u32 s60, s84, 0
    s_add_u32 m0, s86, 0
    s_nop 0
    buffer_load_dwordx4 v8, s[40:43], s60 offen lds
    s_add_u32 s60, s85, 0
    s_add_u32 m0, s62, 0
    s_nop 0
    buffer_load_dwordx4 v10, s[44:47], s60 offen lds
    s_add_u32 s60, s84, 10240
    s_add_u32 m0, s86, 1024
    s_nop 0
    buffer_load_dwordx4 v9, s[40:43], s60 offen lds
    s_add_u32 s60, s84, 20480
    s_add_u32 m0, s86, 2048
    s_nop 0
    buffer_load_dwordx4 v8, s[40:43], s60 offen lds
    s_add_u32 s60, s85, 15360
    s_add_u32 m0, s62, 1024
    s_nop 0
    buffer_load_dwordx4 v10, s[44:47], s60 offen lds
    s_add_u32 s60, s84, 30720
    s_add_u32 m0, s86, 3072
    s_nop 0
    buffer_load_dwordx4 v9, s[40:43], s60 offen lds
    s_add_u32 s60, s85, 30720
    s_add_u32 m0, s62, 2048
    s_nop 0
    buffer_load_dwordx4 v11, s[44:47], s60 offen lds
    s_add_u32 s60, s84, 40960
    s_add_u32 m0, s86, 4096
    s_nop 0
    buffer_load_dwordx4 v8, s[40:43], s60 offen lds
    s_add_u32 s60, s84, 51200
    s_add_u32 m0, s86, 5120
    s_nop 0
    buffer_load_dwordx4 v9, s[40:43], s60 offen lds
    s_add_u32 s60, s85, 46080
    s_add_u32 m0, s62, 3072
    s_nop 0
    buffer_load_dwordx4 v11, s[44:47], s60 offen lds
    s_add_u32 s81, s81, 1
    s_cmp_eq_u32 s81, 10
    s_cselect_b32 s81, 0, s81
    s_add_u32 s94, s94, 40960
    s_cmp_eq_u32 s94, 163840
    s_cselect_b32 s94, 0, s94
    s_waitcnt vmcnt(20)
    s_barrier
    s_lshl_b32 s84, s81, 7
    s_mul_i32 s85, s81, 245760
    s_add_u32 s86, s90, s94
    s_add_u32 s62, s91, s94
    s_add_u32 s60, s84, 0
    s_add_u32 m0, s86, 0
    s_nop 0
    buffer_load_dwordx4 v8, s[40:43], s60 offen lds
    s_add_u32 s60, s85, 0
    s_add_u32 m0, s62, 0
    s_nop 0
    buffer_load_dwordx4 v10, s[44:47], s60 offen lds
    s_add_u32 s60, s84, 10240
    s_add_u32 m0, s86, 1024
    s_nop 0
    buffer_load_dwordx4 v9, s[40:43], s60 offen lds
    s_add_u32 s60, s84, 20480
    s_add_u32 m0, s86, 2048
    s_nop 0
    buffer_load_dwordx4 v8, s[40:43], s60 offen lds
    s_add_u32 s60, s85, 15360
    s_add_u32 m0, s62, 1024
    s_nop 0
    buffer_load_dwordx4 v10, s[44:47], s60 offen lds
    s_add_u32 s60, s84, 30720
    s_add_u32 m0, s86, 3072
    s_nop 0
    buffer_load_dwordx4 v9, s[40:43], s60 offen lds
    s_add_u32 s60, s85, 30720
    s_add_u32 m0, s62, 2048
    s_nop 0
    buffer_load_dwordx4 v11, s[44:47], s60 offen lds
    s_add_u32 s60, s84, 40960
    s_add_u32 m0, s86, 4096
    s_nop 0
    buffer_load_dwordx4 v8, s[40:43], s60 offen lds
    s_add_u32 s60, s84, 51200
    s_add_u32 m0, s86, 5120
    s_nop 0
    buffer_load_dwordx4 v9, s[40:43], s60 offen lds
    s_add_u32 s60, s85, 46080
    s_add_u32 m0, s62, 3072
    s_nop 0
    buffer_load_dwordx4 v11, s[44:47], s60 offen lds
    s_add_u32 s81, s81, 1
    s_cmp_eq_u32 s81, 10
    s_cselect_b32 s81, 0, s81
    s_add_u32 s94, s94, 40960
    s_cmp_eq_u32 s94, 163840
    s_cselect_b32 s94, 0, s94
    s_waitcnt vmcnt(20)
    s_barrier
    s_waitcnt vmcnt(10)
    s_barrier
    s_waitcnt vmcnt(0)
    s_barrier
    s_mul_i32 s60, s35, 12
    s_mul_i32 s61, s38, 3
    s_add_u32 s60, s60, s61
    s_mul_i32 s60, s60, 20480
    s_mul_i32 s61, s80, 1280
    s_add_u32 s60, s60, s61
    s_add_u32 s60, s60, 1048576
    v_lshl_add_u32 v16, v1, 4, s60
    s_add_u32 s60, s60, 1024
    v_lshl_add_u32 v17, v1, 2, s60
    s_mov_b32 s61, 0
    buffer_store_dwordx4 v[12:15], v16, s[48:51], s61 offen sc1
    s_mov_b32 s61, 0
    buffer_store_dword v12, v17, s[48:51], s61 offen sc1
    s_mov_b32 s61, 20480
    buffer_store_dwordx4 v[12:15], v16, s[48:51], s61 offen sc1
    s_mov_b32 s61, 20480
    buffer_store_dword v12, v17, s[48:51], s61 offen sc1
    s_mov_b32 s61, 40960
    buffer_store_dwordx4 v[12:15], v16, s[48:51], s61 offen sc1
    s_mov_b32 s61, 40960
    buffer_store_dword v12, v17, s[48:51], s61 offen sc1
    s_lshr_b32 s60, s2, 3
    s_cmp_ge_u32 s60, 20
    s_cbranch_scc1 L_p_nopf
    s_mul_i32 s60, s60, 320
    s_mul_i32 s61, s38, 80
    s_add_u32 s60, s60, s61
    v_add_u32 v4, s60, v1
    v_lshlrev_b32 v4, 7, v4
    buffer_load_dword v167, v4, s[52:55], 0 offen
    s_mov_b32 exec_lo, 0xffff
    s_mov_b32 exec_hi, 0
    v_add_u32 v4, 8192, v4
    buffer_load_dword v167, v4, s[52:55], 0 offen
    s_mov_b64 exec, -1
L_p_nopf:
    s_cmp_lg_u32 s38, 0
    s_cbranch_scc1 L_p_clr_okp
    s_mov_b32 s101, 0
    s_mov_b32 exec_lo, 1
    s_mov_b32 exec_hi, 0
    v_mov_b32 v4, 4
L_p_clrp:
    global_load_dword v5, v4, s[28:29] sc1
    s_waitcnt vmcnt(0)
    v_readfirstlane_b32 s60, v5
    s_nop 3
    s_cmp_ge_u32 s60, 176
    s_cbranch_scc1 L_p_clr_okp
    s_add_u32 s101, s101, 1
    s_cmp_gt_u32 s101, 4096
    s_cbranch_scc1 L_p_clr_okp
    s_sleep 16
    s_branch L_p_clrp
L_p_clr_okp:
    s_mov_b64 exec, -1
    s_waitcnt vmcnt(0)
    s_lshr_b32 s60, s2, 3
    s_cmp_ge_u32 s60, 10
    s_cselect_b32 s61, 1, 0
    s_mul_i32 s61, s61, 10
    s_sub_u32 s93, s60, s61
    v_lshrrev_b32 v4, 3, v1
    v_bfe_u32 v5, v4, 1, 1
    v_lshlrev_b32 v5, 1, v5
    v_and_b32 v6, 7, v1
    v_xor_b32 v5, v5, v6
    v_xor_b32 v6, 4, v5
    v_lshrrev_b32 v7, 2, v4
    v_mul_u32_u24 v7, 20, v7
    v_and_b32 v4, 3, v4
    v_add_u32 v4, v4, v7
    s_mul_i32 s60, s38, 160
    v_add_u32 v4, s60, v4
    v_mul_u32_u24 v4, 1280, v4
    s_lshl_b32 s60, s93, 7
    v_add_u32 v4, s60, v4
    v_lshl_add_u32 v7, v6, 4, v4
    v_lshl_add_u32 v4, v5, 4, v4
    s_mul_i32 s86, s38, 20480
    s_barrier
    v_mov_b32 v18, v4
    v_mov_b32 v19, v7
    s_cmp_lg_u32 s38, 0
    s_cbranch_scc1 L_p_nocnto
    v_mov_b32 v4, 128
    v_mov_b32 v5, 1
    s_mov_b32 exec_lo, 1
    s_mov_b32 exec_hi, 0
    global_atomic_add v4, v5, s[28:29] sc1
    s_mov_b64 exec, -1
L_p_nocnto:
    s_cmp_ge_u32 s2, 160
    s_cbranch_scc1 L_p_nowo
    s_mov_b32 s61, 0
    s_add_u32 m0, s86, 0
    s_nop 0
    buffer_load_dwordx4 v18, s[52:55], s61 offen lds
    s_mov_b32 s61, 5120
    s_add_u32 m0, s86, 1024
    s_nop 0
    buffer_load_dwordx4 v19, s[52:55], s61 offen lds
    s_mov_b32 s61, 10240
    s_add_u32 m0, s86, 2048
    s_nop 0
    buffer_load_dwordx4 v18, s[52:55], s61 offen lds
    s_mov_b32 s61, 15360
    s_add_u32 m0, s86, 3072
    s_nop 0
    buffer_load_dwordx4 v19, s[52:55], s61 offen lds
    s_mov_b32 s61, 20480
    s_add_u32 m0, s86, 4096
    s_nop 0
    buffer_load_dwordx4 v18, s[52:55], s61 offen lds
    s_mov_b32 s61, 51200
    s_add_u32 m0, s86, 5120
    s_nop 0
    buffer_load_dwordx4 v19, s[52:55], s61 offen lds
    s_mov_b32 s61, 56320
    s_add_u32 m0, s86, 6144
    s_nop 0
    buffer_load_dwordx4 v18, s[52:55], s61 offen lds
    s_mov_b32 s61, 61440
    s_add_u32 m0, s86, 7168
    s_nop 0
    buffer_load_dwordx4 v19, s[52:55], s61 offen lds
    s_mov_b32 s61, 66560
    s_add_u32 m0, s86, 8192
    s_nop 0
    buffer_load_dwordx4 v18, s[52:55], s61 offen lds
    s_mov_b32 s61, 71680
    s_add_u32 m0, s86, 9216
    s_nop 0
    buffer_load_dwordx4 v19, s[52:55], s61 offen lds
    s_mov_b32 s61, 102400
    s_add_u32 m0, s86, 10240
    s_nop 0
    buffer_load_dwordx4 v18, s[52:55], s61 offen lds
    s_mov_b32 s61, 107520
    s_add_u32 m0, s86, 11264
    s_nop 0
    buffer_load_dwordx4 v19, s[52:55], s61 offen lds
    s_mov_b32 s61, 112640
    s_add_u32 m0, s86, 12288
    s_nop 0
    buffer_load_dwordx4 v18, s[52:55], s61 offen lds
    s_mov_b32 s61, 117760
    s_add_u32 m0, s86, 13312
    s_nop 0
    buffer_load_dwordx4 v19, s[52:55], s61 offen lds
    s_mov_b32 s61, 122880
    s_add_u32 m0, s86, 14336
    s_nop 0
    buffer_load_dwordx4 v18, s[52:55], s61 offen lds
    s_mov_b32 s61, 153600
    s_add_u32 m0, s86, 15360
    s_nop 0
    buffer_load_dwordx4 v19, s[52:55], s61 offen lds
    s_mov_b32 s61, 158720
    s_add_u32 m0, s86, 16384
    s_nop 0
    buffer_load_dwordx4 v18, s[52:55], s61 offen lds
    s_mov_b32 s61, 163840
    s_add_u32 m0, s86, 17408
    s_nop 0
    buffer_load_dwordx4 v19, s[52:55], s61 offen lds
    s_mov_b32 s61, 168960
    s_add_u32 m0, s86, 18432
    s_nop 0
    buffer_load_dwordx4 v18, s[52:55], s61 offen lds
    s_mov_b32 s61, 174080
    s_add_u32 m0, s86, 19456
    s_nop 0
    buffer_load_dwordx4 v19, s[52:55], s61 offen lds
L_p_nowo:
    s_waitcnt vmcnt(0)
    s_barrier
    s_endpgm
L_b_compute:
    s_cmp_eq_u32 s39, 0
    s_cselect_b32 s60, s36, s80
    s_mul_i32 s60, s60, 1600
    v_lshlrev_b32 v4, 4, v1
    v_add_u32 v4, s60, v4
    v_add_u32 v5, 1024, v4
    s_waitcnt lgkmcnt(0)
    global_load_dwordx4 v[8:11], v4, s[22:23]
    s_mov_b32 exec_hi, 15
    global_load_dwordx4 v[12:15], v5, s[22:23]
    s_mov_b32 exec_hi, -1
    s_mov_b32 s48, s30
    s_and_b32 s49, s31, 0xffff
    s_mov_b32 s50, 16777216
    s_mov_b32 s51, 0x00020000
    s_mov_b32 s56, s26
    s_and_b32 s57, s27, 0xffff
    s_mov_b32 s58, 5242880
    s_mov_b32 s59, 0x00020000
    s_mov_b32 s88, 0x3fb8aa3b
    s_mov_b32 s89, 0x3fb8aa3b
    s_mov_b32 s100, 0xfffe2000
    v_add_u32 v4, 0, v3
    v_lshrrev_b32 v5, 1, v2
    v_xor_b32 v4, v4, v5
    v_lshlrev_b32 v4, 4, v4
    s_mul_i32 s60, s38, 48
    v_add_u32 v5, s60, v2
    v_lshl_add_u32 v16, v5, 7, v4
    v_add_u32 v4, 4, v3
    v_lshrrev_b32 v5, 1, v2
    v_xor_b32 v4, v4, v5
    v_lshlrev_b32 v4, 4, v4
    s_mul_i32 s60, s38, 48
    v_add_u32 v5, s60, v2
    v_lshl_add_u32 v17, v5, 7, v4
    v_and_b32 v4, 1, v3
    v_xor_b32 v4, s39, v4
    v_lshlrev_b32 v4, 7, v4
    v_bfe_u32 v6, v2, 1, 1
    v_lshl_add_u32 v4, v6, 4, v4
    v_and_b32 v6, 1, v2
    v_lshl_add_u32 v4, v6, 3, v4
    v_lshrrev_b32 v5, 2, v2
    v_lshl_add_u32 v6, v3, 3, v5
    v_lshl_add_u32 v4, v6, 8, v4
    v_add_u32 v4, 24576, v4
    v_xor_b32 v6, 0, v5
    v_lshl_add_u32 v18, v6, 5, v4
    v_xor_b32 v6, 1, v5
    v_lshl_add_u32 v19, v6, 5, v4
    v_xor_b32 v6, 2, v5
    v_lshl_add_u32 v20, v6, 5, v4
    v_xor_b32 v6, 3, v5
    v_lshl_add_u32 v21, v6, 5, v4
    v_mov_b32 v24, 0
    v_mov_b32 v25, 0
    v_mov_b32 v26, 0
    v_mov_b32 v27, 0
    v_mov_b32 v28, 0
    v_mov_b32 v29, 0
    v_mov_b32 v30, 0
    v_mov_b32 v31, 0
    v_mov_b32 v32, 0
    v_mov_b32 v33, 0
    v_mov_b32 v34, 0
    v_mov_b32 v35, 0
    v_mov_b32 v36, 0
    v_mov_b32 v37, 0
    v_mov_b32 v38, 0
    v_mov_b32 v39, 0
    v_mov_b32 v40, 0
    v_mov_b32 v41, 0
    v_mov_b32 v42, 0
    v_mov_b32 v43, 0
    v_mov_b32 v44, 0
    v_mov_b32 v45, 0
    v_mov_b32 v46, 0
    v_mov_b32 v47, 0
    v_mov_b32 v48, 0
    v_mov_b32 v49, 0
    v_mov_b32 v50, 0
    v_mov_b32 v51, 0
    v_mov_b32 v52, 0
    v_mov_b32 v53, 0
    v_mov_b32 v54, 0
    v_mov_b32 v55, 0
    v_mov_b32 v56, 0
    v_mov_b32 v57, 0
    v_mov_b32 v58, 0
    v_mov_b32 v59, 0
    v_mov_b32 v60, 0
    v_mov_b32 v61, 0
    v_mov_b32 v62, 0
    v_mov_b32 v63, 0
    v_mov_b32 v64, 0
    v_mov_b32 v65, 0
    v_mov_b32 v66, 0
    v_mov_b32 v67, 0
    v_mov_b32 v68, 0
    v_mov_b32 v69, 0
    v_mov_b32 v70, 0
    v_mov_b32 v71, 0
    v_mov_b32 v88, 0
    v_mov_b32 v89, 0
    v_mov_b32 v90, 0
    v_mov_b32 v91, 0
    v_mov_b32 v92, 0
    v_mov_b32 v93, 0
    v_mov_b32 v94, 0
    v_mov_b32 v95, 0
    v_mov_b32 v96, 0
    v_mov_b32 v97, 0
    v_mov_b32 v98, 0
    v_mov_b32 v99, 0
    v_mov_b32 v100, 0
    v_mov_b32 v101, 0
    v_mov_b32 v102, 0
    v_mov_b32 v103, 0
    v_mov_b32 v104, 0
    v_mov_b32 v105, 0
    v_mov_b32 v106, 0
    v_mov_b32 v107, 0
    v_mov_b32 v108, 0
    v_mov_b32 v109, 0
    v_mov_b32 v110, 0
    v_mov_b32 v111, 0
    v_mov_b32 v112, 0
    v_mov_b32 v113, 0
    v_mov_b32 v114, 0
    v_mov_b32 v115, 0
    v_mov_b32 v116, 0
    v_mov_b32 v117, 0
    v_mov_b32 v118, 0
    v_mov_b32 v119, 0
    s_lshl_b32 s60, s37, 11
    s_add_u32 s60, s60, 122880
    v_lshl_add_u32 v4, v1, 4, s60
    v_lshrrev_b32 v5, 2, v2
    v_mul_u32_u24 v5, 5, v5
    v_and_b32 v6, 3, v2
    v_add_u32 v6, v5, v6
    v_lshlrev_b32 v6, 1, v6
    v_mul_u32_u24 v7, 160, v3
    v_add3_u32 v6, v6, v7, s60
    v_add_u32 v5, 4, v5
    v_lshlrev_b32 v5, 1, v5
    v_add3_u32 v5, v5, v7, s60
    s_waitcnt vmcnt(0)
    ds_write_b128 v4, v[8:11]
    s_mov_b32 exec_hi, 15
    ds_write_b128 v4, v[12:15] offset:1024
    s_mov_b32 exec_hi, -1
    s_waitcnt lgkmcnt(0)
    s_mov_b32 exec_lo, 0xffffffff
    s_mov_b32 exec_hi, 0xffffffff
    ds_read_u16 v88, v6 offset:0
    ds_read_u16 v89, v6 offset:40
    ds_read_u16 v90, v6 offset:80
    ds_read_u16 v91, v6 offset:120
    s_mov_b32 exec_lo, 0xffff
    s_mov_b32 exec_hi, 0x0
    ds_read_u16 v92, v6 offset:640
    ds_read_u16 v93, v6 offset:680
    ds_read_u16 v94, v6 offset:720
    ds_read_u16 v95, v6 offset:760
    s_mov_b32 exec_lo, 0xffff0000
    s_mov_b32 exec_hi, 0xffffffff
    ds_read_u16 v96, v6 offset:640
    ds_read_u16 v97, v6 offset:680
    ds_read_u16 v98, v6 offset:720
    ds_read_u16 v99, v6 offset:760
    s_mov_b32 exec_lo, 0xffffffff
    s_mov_b32 exec_hi, 0x0
    ds_read_u16 v100, v6 offset:1280
    ds_read_u16 v101, v6 offset:1320
    ds_read_u16 v102, v6 offset:1360
    ds_read_u16 v103, v6 offset:1400
    s_mov_b32 exec_lo, 0x11111111
    s_mov_b32 exec_hi, 0x11111111
    ds_read_u16 v104, v5 offset:0
    ds_read_u16 v105, v5 offset:40
    ds_read_u16 v106, v5 offset:80
    ds_read_u16 v107, v5 offset:120
    s_mov_b32 exec_lo, 0x1111
    s_mov_b32 exec_hi, 0x0
    ds_read_u16 v108, v5 offset:640
    ds_read_u16 v109, v5 offset:680
    ds_read_u16 v110, v5 offset:720
    ds_read_u16 v111, v5 offset:760
    s_mov_b32 exec_lo, 0x22220000
    s_mov_b32 exec_hi, 0x22222222
    ds_read_u16 v112, v5 offset:640
    ds_read_u16 v113, v5 offset:680
    ds_read_u16 v114, v5 offset:720
    ds_read_u16 v115, v5 offset:760
    s_mov_b32 exec_lo, 0x22222222
    s_mov_b32 exec_hi, 0x0
    ds_read_u16 v116, v5 offset:1280
    ds_read_u16 v117, v5 offset:1320
    ds_read_u16 v118, v5 offset:1360
    ds_read_u16 v119, v5 offset:1400
    s_mov_b64 exec, -1
    s_waitcnt lgkmcnt(0)
    v_lshl_or_b32 v72, v89, 16, v88
    v_lshl_or_b32 v73, v91, 16, v90
    v_lshl_or_b32 v74, v93, 16, v92
    v_lshl_or_b32 v75, v95, 16, v94
    v_lshl_or_b32 v76, v97, 16, v96
    v_lshl_or_b32 v77, v99, 16, v98
    v_lshl_or_b32 v78, v101, 16, v100
    v_lshl_or_b32 v79, v103, 16, v102
    v_lshl_or_b32 v80, v105, 16, v104
    v_lshl_or_b32 v81, v107, 16, v106
    v_lshl_or_b32 v82, v109, 16, v108
    v_lshl_or_b32 v83, v111, 16, v110
    v_lshl_or_b32 v84, v113, 16, v112
    v_lshl_or_b32 v85, v115, 16, v114
    v_lshl_or_b32 v86, v117, 16, v116
    v_lshl_or_b32 v87, v119, 16, v118
    s_barrier
    ds_read_b64_tr_b16 v[112:113], v18 offset:0
    ds_read_b64_tr_b16 v[114:115], v18 offset:1024
    ds_read_b128 v[88:91], v16 offset:0
    ds_read_b128 v[92:95], v16 offset:2048
    ds_read_b128 v[96:99], v16 offset:4096
    ds_read_b64_tr_b16 v[116:117], v19 offset:0
    ds_read_b64_tr_b16 v[118:119], v19 offset:1024
    ds_read_b64_tr_b16 v[120:121], v20 offset:0
    ds_read_b64_tr_b16 v[122:123], v20 offset:1024
    ds_read_b64_tr_b16 v[124:125], v21 offset:0
    ds_read_b64_tr_b16 v[126:127], v21 offset:1024
    s_mov_b32 s82, 0
L_b_main:
    s_waitcnt lgkmcnt(0)
    v_mfma_f32_16x16x32_bf16 v[24:27], v[112:115], v[88:91], v[24:27]
    ds_read_b64_tr_b16 v[128:129], v18 offset:8192
    ds_read_b64_tr_b16 v[130:131], v18 offset:9216
    v_mfma_f32_16x16x32_bf16 v[40:43], v[112:115], v[92:95], v[40:43]
    ds_read_b128 v[100:103], v17 offset:0
    ds_read_b128 v[104:107], v17 offset:2048
    v_mfma_f32_16x16x32_bf16 v[56:59], v[112:115], v[96:99], v[56:59]
    ds_read_b128 v[108:111], v17 offset:4096
    ds_read_b64_tr_b16 v[132:133], v19 offset:8192
    v_mfma_f32_16x16x32_bf16 v[28:31], v[116:119], v[88:91], v[28:31]
    ds_read_b64_tr_b16 v[134:135], v19 offset:9216
    ds_read_b64_tr_b16 v[136:137], v20 offset:8192
    v_mfma_f32_16x16x32_bf16 v[44:47], v[116:119], v[92:95], v[44:47]
    ds_read_b64_tr_b16 v[138:139], v20 offset:9216
    ds_read_b64_tr_b16 v[140:141], v21 offset:8192
    v_mfma_f32_16x16x32_bf16 v[60:63], v[116:119], v[96:99], v[60:63]
    ds_read_b64_tr_b16 v[142:143], v21 offset:9216
    v_mfma_f32_16x16x32_bf16 v[32:35], v[120:123], v[88:91], v[32:35]
    v_mfma_f32_16x16x32_bf16 v[48:51], v[120:123], v[92:95], v[48:51]
    s_and_b32 s60, s82, 3
    s_cmp_eq_u32 s60, 3
    s_cselect_b32 s83, s100, 40960
    v_mfma_f32_16x16x32_bf16 v[64:67], v[120:123], v[96:99], v[64:67]
    v_mfma_f32_16x16x32_bf16 v[36:39], v[124:127], v[88:91], v[36:39]
    v_mfma_f32_16x16x32_bf16 v[52:55], v[124:127], v[92:95], v[52:55]
    v_mfma_f32_16x16x32_bf16 v[68:71], v[124:127], v[96:99], v[68:71]
    s_waitcnt lgkmcnt(0)
    s_barrier
    v_mfma_f32_16x16x32_bf16 v[24:27], v[128:131], v[100:103], v[24:27]
    v_add_u32 v18, s83, v18
    v_add_u32 v16, s83, v16
    v_add_u32 v19, s83, v19
    v_add_u32 v20, s83, v20
    v_add_u32 v21, s83, v21
    v_add_u32 v17, s83, v17
    v_mfma_f32_16x16x32_bf16 v[40:43], v[128:131], v[104:107], v[40:43]
    ds_read_b64_tr_b16 v[112:113], v18 offset:0
    ds_read_b64_tr_b16 v[114:115], v18 offset:1024
    v_mfma_f32_16x16x32_bf16 v[56:59], v[128:131], v[108:111], v[56:59]
    ds_read_b128 v[88:91], v16 offset:0
    ds_read_b128 v[92:95], v16 offset:2048
    v_mfma_f32_16x16x32_bf16 v[28:31], v[132:135], v[100:103], v[28:31]
    ds_read_b128 v[96:99], v16 offset:4096
    ds_read_b64_tr_b16 v[116:117], v19 offset:0
    v_mfma_f32_16x16x32_bf16 v[44:47], v[132:135], v[104:107], v[44:47]
    ds_read_b64_tr_b16 v[118:119], v19 offset:1024
    ds_read_b64_tr_b16 v[120:121], v20 offset:0
    v_mfma_f32_16x16x32_bf16 v[60:63], v[132:135], v[108:111], v[60:63]
    ds_read_b64_tr_b16 v[122:123], v20 offset:1024
    ds_read_b64_tr_b16 v[124:125], v21 offset:0
    v_mfma_f32_16x16x32_bf16 v[32:35], v[136:139], v[100:103], v[32:35]
    ds_read_b64_tr_b16 v[126:127], v21 offset:1024
    v_mfma_f32_16x16x32_bf16 v[48:51], v[136:139], v[104:107], v[48:51]
    v_mfma_f32_16x16x32_bf16 v[64:67], v[136:139], v[108:111], v[64:67]
    v_mfma_f32_16x16x32_bf16 v[36:39], v[140:143], v[100:103], v[36:39]
    v_mfma_f32_16x16x32_bf16 v[52:55], v[140:143], v[104:107], v[52:55]
    v_mfma_f32_16x16x32_bf16 v[68:71], v[140:143], v[108:111], v[68:71]
    s_add_u32 s82, s82, 1
    s_cmp_lt_u32 s82, 9
    s_cbranch_scc1 L_b_main
    s_waitcnt lgkmcnt(0)
    v_mfma_f32_16x16x32_bf16 v[24:27], v[112:115], v[88:91], v[24:27]
    ds_read_b64_tr_b16 v[128:129], v18 offset:8192
    ds_read_b64_tr_b16 v[130:131], v18 offset:9216
    v_mfma_f32_16x16x32_bf16 v[40:43], v[112:115], v[92:95], v[40:43]
    ds_read_b128 v[100:103], v17 offset:0
    ds_read_b128 v[104:107], v17 offset:2048
    v_mfma_f32_16x16x32_bf16 v[56:59], v[112:115], v[96:99], v[56:59]
    ds_read_b128 v[108:111], v17 offset:4096
    ds_read_b64_tr_b16 v[132:133], v19 offset:8192
    v_mfma_f32_16x16x32_bf16 v[28:31], v[116:119], v[88:91], v[28:31]
    ds_read_b64_tr_b16 v[134:135], v19 offset:9216
    ds_read_b64_tr_b16 v[136:137], v20 offset:8192
    v_mfma_f32_16x16x32_bf16 v[44:47], v[116:119], v[92:95], v[44:47]
    ds_read_b64_tr_b16 v[138:139], v20 offset:9216
    ds_read_b64_tr_b16 v[140:141], v21 offset:8192
    v_mfma_f32_16x16x32_bf16 v[60:63], v[116:119], v[96:99], v[60:63]
    ds_read_b64_tr_b16 v[142:143], v21 offset:9216
    v_mfma_f32_16x16x32_bf16 v[32:35], v[120:123], v[88:91], v[32:35]
    v_mfma_f32_16x16x32_bf16 v[48:51], v[120:123], v[92:95], v[48:51]
    s_and_b32 s60, s82, 3
    s_cmp_eq_u32 s60, 3
    s_cselect_b32 s83, s100, 40960
    v_mfma_f32_16x16x32_bf16 v[64:67], v[120:123], v[96:99], v[64:67]
    v_mfma_f32_16x16x32_bf16 v[36:39], v[124:127], v[88:91], v[36:39]
    v_mfma_f32_16x16x32_bf16 v[52:55], v[124:127], v[92:95], v[52:55]
    v_mfma_f32_16x16x32_bf16 v[68:71], v[124:127], v[96:99], v[68:71]
    s_waitcnt lgkmcnt(0)
    v_mfma_f32_16x16x32_bf16 v[24:27], v[128:131], v[100:103], v[24:27]
    v_mfma_f32_16x16x32_bf16 v[40:43], v[128:131], v[104:107], v[40:43]
    v_mfma_f32_16x16x32_bf16 v[56:59], v[128:131], v[108:111], v[56:59]
    v_mfma_f32_16x16x32_bf16 v[28:31], v[132:135], v[100:103], v[28:31]
    v_mfma_f32_16x16x32_bf16 v[44:47], v[132:135], v[104:107], v[44:47]
    v_mfma_f32_16x16x32_bf16 v[60:63], v[132:135], v[108:111], v[60:63]
    v_mfma_f32_16x16x32_bf16 v[32:35], v[136:139], v[100:103], v[32:35]
    v_mfma_f32_16x16x32_bf16 v[48:51], v[136:139], v[104:107], v[48:51]
    v_mfma_f32_16x16x32_bf16 v[64:67], v[136:139], v[108:111], v[64:67]
    v_mfma_f32_16x16x32_bf16 v[36:39], v[140:143], v[100:103], v[36:39]
    v_mfma_f32_16x16x32_bf16 v[52:55], v[140:143], v[104:107], v[52:55]
    v_mfma_f32_16x16x32_bf16 v[68:71], v[140:143], v[108:111], v[68:71]
    s_mul_i32 s60, s38, 48
    v_add_u32 v4, s60, v2
    v_mul_u32_u24 v8, 296, v4
    v_add_u32 v8, 81920, v8
    s_mul_i32 s60, s39, 48
    v_lshlrev_b32 v5, 3, v3
    v_add3_u32 v9, v5, v8, s60
    v_add_u32 v9, 176, v9
    v_add_u32 v6, 208, v5
    v_add_u32 v7, 256, v5
    v_cmp_gt_u32 vcc, 2, v3
    v_add_u32 v10, 264, v5
    s_nop 0
    v_cndmask_b32 v7, v10, v7, vcc
    s_cmp_eq_u32 s39, 0
    s_cselect_b64 vcc, -1, 0
    v_cndmask_b32 v7, v7, v6, vcc
    v_add_u32 v10, v7, v8
    v_cvt_pk_bf16_f32 v92, v32, v33
    v_cvt_pk_bf16_f32 v93, v34, v35
    v_cvt_pk_bf16_f32 v94, v36, v37
    v_cvt_pk_bf16_f32 v95, v38, v39
    v_cvt_pk_bf16_f32 v100, v48, v49
    v_cvt_pk_bf16_f32 v101, v50, v51
    v_cvt_pk_bf16_f32 v102, v52, v53
    v_cvt_pk_bf16_f32 v103, v54, v55
    v_cvt_pk_bf16_f32 v108, v64, v65
    v_cvt_pk_bf16_f32 v109, v66, v67
    v_cvt_pk_bf16_f32 v110, v68, v69
    v_cvt_pk_bf16_f32 v111, v70, v71
    s_mov_b32 exec_lo, 0
    ds_write_b64 v9, v[92:93] offset:0
    ds_write_b64 v9, v[100:101] offset:4736
    ds_write_b64 v9, v[108:109] offset:9472
    s_mov_b32 exec_lo, -1
    ds_write_b64 v10, v[94:95] offset:0
    ds_write_b64 v10, v[102:103] offset:4736
    ds_write_b64 v10, v[110:111] offset:9472
    v_cvt_pk_bf16_f32 v88, v24, v25
    v_cvt_pk_bf16_f32 v89, v26, v27
    v_cvt_pk_bf16_f32 v90, v28, v29
    v_cvt_pk_bf16_f32 v91, v30, v31
    v_cvt_pk_bf16_f32 v96, v40, v41
    v_cvt_pk_bf16_f32 v97, v42, v43
    v_cvt_pk_bf16_f32 v98, v44, v45
    v_cvt_pk_bf16_f32 v99, v46, v47
    v_cvt_pk_bf16_f32 v104, v56, v57
    v_cvt_pk_bf16_f32 v105, v58, v59
    v_cvt_pk_bf16_f32 v106, v60, v61
    v_cvt_pk_bf16_f32 v107, v62, v63
    s_cmp_eq_u32 s39, 0
    s_cbranch_scc0 L_b_qtype
    s_mul_i32 s60, s38, 48
    s_add_u32 s60, s60, s87
    v_add_u32 v4, s60, v2
    v_mov_b32 v5, 0x3f80
    v_mov_b32 v51, 0
    v_cmp_gt_u32 vcc, 0x800, v4
    s_nop 1
    v_cndmask_b32 v50, 0, v5, vcc
    ds_write_b64 v8, v[50:51] offset:272
    v_add_u32 v4, 16, v4
    v_cmp_gt_u32 vcc, 0x800, v4
    s_nop 1
    v_cndmask_b32 v50, 0, v5, vcc
    ds_write_b64 v8, v[50:51] offset:5008
    v_add_u32 v4, 16, v4
    v_cmp_gt_u32 vcc, 0x800, v4
    s_nop 1
    v_cndmask_b32 v50, 0, v5, vcc
    ds_write_b64 v8, v[50:51] offset:9744
    v_add_u32 v4, 16, v4
    v_mul_u32_u24 v4, 24, v3
    v_add_u32 v9, v4, v8
    v_mfma_f32_16x16x32_bf16 v[12:15], v[72:75], v[88:91], 0
    v_mfma_f32_16x16x32_bf16 v[24:27], v[72:75], v[96:99], 0
    v_mfma_f32_16x16x32_bf16 v[36:39], v[72:75], v[104:107], 0
    v_mfma_f32_16x16x32_bf16 v[20:23], v[80:83], v[88:91], 0
    v_mfma_f32_16x16x32_bf16 v[32:35], v[80:83], v[96:99], 0
    v_mfma_f32_16x16x32_bf16 v[44:47], v[80:83], v[104:107], 0
    v_mfma_f32_16x16x32_bf16 v[16:19], v[76:79], v[90:93], 0
    v_mfma_f32_16x16x32_bf16 v[28:31], v[76:79], v[98:101], 0
    v_mfma_f32_16x16x32_bf16 v[40:43], v[76:79], v[106:109], 0
    v_mfma_f32_16x16x32_bf16 v[20:23], v[84:87], v[90:93], v[20:23]
    v_mfma_f32_16x16x32_bf16 v[32:35], v[84:87], v[98:101], v[32:35]
    v_mfma_f32_16x16x32_bf16 v[44:47], v[84:87], v[106:109], v[44:47]
    v_max3_f32 v10, v12, v13, v14
    v_max3_f32 v154, v24, v25, v26
    v_max3_f32 v160, v36, v37, v38
    v_max3_f32 v70, -v12, -v13, -v14
    v_max3_f32 v156, -v24, -v25, -v26
    v_max3_f32 v162, -v36, -v37, -v38
    v_max3_f32 v11, v16, v17, v18
    v_max3_f32 v155, v28, v29, v30
    v_max3_f32 v161, v40, v41, v42
    v_max3_f32 v71, -v16, -v17, -v18
    v_max3_f32 v157, -v28, -v29, -v30
    v_max3_f32 v163, -v40, -v41, -v42
    v_max3_f32 v10, v10, v15, v20
    v_max3_f32 v154, v154, v27, v32
    v_max3_f32 v160, v160, v39, v44
    v_max3_f32 v70, v70, -v15, -v20
    v_max3_f32 v156, v156, -v27, -v32
    v_max3_f32 v162, v162, -v39, -v44
    v_max3_f32 v11, v11, v19, v21
    v_max3_f32 v155, v155, v31, v33
    v_max3_f32 v161, v161, v43, v45
    v_max3_f32 v71, v71, -v19, -v21
    v_max3_f32 v157, v157, -v31, -v33
    v_max3_f32 v163, v163, -v43, -v45
    v_permlane16_swap_b32 v10, v70
    v_permlane16_swap_b32 v154, v156
    v_permlane16_swap_b32 v160, v162
    v_permlane16_swap_b32 v11, v71
    v_permlane16_swap_b32 v155, v157
    v_permlane16_swap_b32 v161, v163
    v_max_f32 v10, v10, v70
    v_max_f32 v154, v154, v156
    v_max_f32 v160, v160, v162
    v_max_f32 v11, v11, v71
    v_max_f32 v155, v155, v157
    v_max_f32 v161, v161, v163
    v_permlane32_swap_b32 v10, v11
    v_permlane32_swap_b32 v154, v155
    v_permlane32_swap_b32 v160, v161
    v_max_f32 v152, v10, v11
    v_max_f32 v158, v154, v155
    v_max_f32 v164, v160, v161
    v_mul_f32 v152, s88, v152
    v_mul_f32 v158, s88, v158
    v_mul_f32 v164, s88, v164
    v_mov_b32 v153, v152
    v_mov_b32 v159, v158
    v_mov_b32 v165, v164
    v_permlane32_swap_b32 v152, v153
    v_permlane32_swap_b32 v158, v159
    v_permlane32_swap_b32 v164, v165
    v_mov_b32 v10, v152
    v_mov_b32 v154, v158
    v_mov_b32 v160, v164
    v_mov_b32 v11, v153
    v_mov_b32 v155, v159
    v_mov_b32 v161, v165
    v_permlane16_swap_b32 v10, v152
    v_permlane16_swap_b32 v154, v158
    v_permlane16_swap_b32 v160, v164
    v_permlane16_swap_b32 v11, v153
    v_permlane16_swap_b32 v155, v159
    v_permlane16_swap_b32 v161, v165
    v_pk_fma_f32 v[50:51], v[12:13], s[88:89], v[10:11] op_sel:[0,0,0] op_sel_hi:[1,1,0] neg_lo:[0,0,1] neg_hi:[0,0,1]
    v_pk_fma_f32 v[112:113], v[24:25], s[88:89], v[154:155] op_sel:[0,0,0] op_sel_hi:[1,1,0] neg_lo:[0,0,1] neg_hi:[0,0,1]
    v_pk_fma_f32 v[132:133], v[36:37], s[88:89], v[160:161] op_sel:[0,0,0] op_sel_hi:[1,1,0] neg_lo:[0,0,1] neg_hi:[0,0,1]
    v_pk_fma_f32 v[60:61], v[12:13], s[88:89], v[152:153] op_sel:[0,0,0] op_sel_hi:[1,1,0] neg_lo:[1,0,1] neg_hi:[1,0,1]
    v_pk_fma_f32 v[122:123], v[24:25], s[88:89], v[158:159] op_sel:[0,0,0] op_sel_hi:[1,1,0] neg_lo:[1,0,1] neg_hi:[1,0,1]
    v_pk_fma_f32 v[142:143], v[36:37], s[88:89], v[164:165] op_sel:[0,0,0] op_sel_hi:[1,1,0] neg_lo:[1,0,1] neg_hi:[1,0,1]
    v_pk_fma_f32 v[52:53], v[14:15], s[88:89], v[10:11] op_sel:[0,0,0] op_sel_hi:[1,1,0] neg_lo:[0,0,1] neg_hi:[0,0,1]
    v_pk_fma_f32 v[114:115], v[26:27], s[88:89], v[154:155] op_sel:[0,0,0] op_sel_hi:[1,1,0] neg_lo:[0,0,1] neg_hi:[0,0,1]
    v_pk_fma_f32 v[134:135], v[38:39], s[88:89], v[160:161] op_sel:[0,0,0] op_sel_hi:[1,1,0] neg_lo:[0,0,1] neg_hi:[0,0,1]
    v_pk_fma_f32 v[62:63], v[14:15], s[88:89], v[152:153] op_sel:[0,0,0] op_sel_hi:[1,1,0] neg_lo:[1,0,1] neg_hi:[1,0,1]
    v_pk_fma_f32 v[124:125], v[26:27], s[88:89], v[158:159] op_sel:[0,0,0] op_sel_hi:[1,1,0] neg_lo:[1,0,1] neg_hi:[1,0,1]
    v_pk_fma_f32 v[144:145], v[38:39], s[88:89], v[164:165] op_sel:[0,0,0] op_sel_hi:[1,1,0] neg_lo:[1,0,1] neg_hi:[1,0,1]
    v_fma_f32 v54, v16, s88, -v11
    v_fma_f32 v116, v28, s88, -v155
    v_fma_f32 v136, v40, s88, -v161
    v_fma_f32 v55, v17, s88, -v11
    v_fma_f32 v117, v29, s88, -v155
    v_fma_f32 v137, v41, s88, -v161
    v_fma_f32 v64, -v16, s88, -v153
    v_fma_f32 v126, -v28, s88, -v159
    v_fma_f32 v146, -v40, s88, -v165
    v_fma_f32 v65, -v17, s88, -v153
    v_fma_f32 v127, -v29, s88, -v159
    v_fma_f32 v147, -v41, s88, -v165
    v_fma_f32 v56, v18, s88, -v11
    v_fma_f32 v118, v30, s88, -v155
    v_fma_f32 v138, v42, s88, -v161
    v_fma_f32 v57, v19, s88, -v11
    v_fma_f32 v119, v31, s88, -v155
    v_fma_f32 v139, v43, s88, -v161
    v_fma_f32 v66, -v18, s88, -v153
    v_fma_f32 v128, -v30, s88, -v159
    v_fma_f32 v148, -v42, s88, -v165
    v_fma_f32 v67, -v19, s88, -v153
    v_fma_f32 v129, -v31, s88, -v159
    v_fma_f32 v149, -v43, s88, -v165
    v_pk_fma_f32 v[58:59], v[20:21], s[88:89], v[10:11] op_sel:[0,0,0] op_sel_hi:[1,1,1] neg_lo:[0,0,1] neg_hi:[0,0,1]
    v_pk_fma_f32 v[120:121], v[32:33], s[88:89], v[154:155] op_sel:[0,0,0] op_sel_hi:[1,1,1] neg_lo:[0,0,1] neg_hi:[0,0,1]
    v_pk_fma_f32 v[140:141], v[44:45], s[88:89], v[160:161] op_sel:[0,0,0] op_sel_hi:[1,1,1] neg_lo:[0,0,1] neg_hi:[0,0,1]
    v_pk_fma_f32 v[68:69], v[20:21], s[88:89], v[152:153] op_sel:[0,0,0] op_sel_hi:[1,1,1] neg_lo:[1,0,1] neg_hi:[1,0,1]
    v_pk_fma_f32 v[130:131], v[32:33], s[88:89], v[158:159] op_sel:[0,0,0] op_sel_hi:[1,1,1] neg_lo:[1,0,1] neg_hi:[1,0,1]
    v_pk_fma_f32 v[150:151], v[44:45], s[88:89], v[164:165] op_sel:[0,0,0] op_sel_hi:[1,1,1] neg_lo:[1,0,1] neg_hi:[1,0,1]
    v_exp_f32 v50, v50
    v_exp_f32 v112, v112
    v_exp_f32 v132, v132
    v_exp_f32 v51, v51
    v_exp_f32 v113, v113
    v_exp_f32 v133, v133
    v_exp_f32 v52, v52
    v_exp_f32 v114, v114
    v_exp_f32 v134, v134
    v_exp_f32 v53, v53
    v_exp_f32 v115, v115
    v_exp_f32 v135, v135
    v_exp_f32 v54, v54
    v_exp_f32 v116, v116
    v_exp_f32 v136, v136
    v_exp_f32 v55, v55
    v_exp_f32 v117, v117
    v_exp_f32 v137, v137
    v_exp_f32 v56, v56
    v_exp_f32 v118, v118
    v_exp_f32 v138, v138
    v_exp_f32 v57, v57
    v_exp_f32 v119, v119
    v_exp_f32 v139, v139
    v_exp_f32 v58, v58
    v_exp_f32 v120, v120
    v_exp_f32 v140, v140
    v_exp_f32 v59, v59
    v_exp_f32 v121, v121
    v_exp_f32 v141, v141
    v_exp_f32 v60, v60
    v_exp_f32 v122, v122
    v_exp_f32 v142, v142
    v_exp_f32 v61, v61
    v_exp_f32 v123, v123
    v_exp_f32 v143, v143
    v_exp_f32 v62, v62
    v_exp_f32 v124, v124
    v_exp_f32 v144, v144
    v_exp_f32 v63, v63
    v_exp_f32 v125, v125
    v_exp_f32 v145, v145
    v_exp_f32 v64, v64
    v_exp_f32 v126, v126
    v_exp_f32 v146, v146
    v_exp_f32 v65, v65
    v_exp_f32 v127, v127
    v_exp_f32 v147, v147
    v_exp_f32 v66, v66
    v_exp_f32 v128, v128
    v_exp_f32 v148, v148
    v_exp_f32 v67, v67
    v_exp_f32 v129, v129
    v_exp_f32 v149, v149
    v_exp_f32 v68, v68
    v_exp_f32 v130, v130
    v_exp_f32 v150, v150
    v_exp_f32 v69, v69
    v_exp_f32 v131, v131
    v_exp_f32 v151, v151
    v_pk_add_f32 v[12:13], v[50:51], v[52:53]
    v_pk_add_f32 v[24:25], v[112:113], v[114:115]
    v_pk_add_f32 v[36:37], v[132:133], v[134:135]
    v_pk_add_f32 v[14:15], v[54:55], v[56:57]
    v_pk_add_f32 v[26:27], v[116:117], v[118:119]
    v_pk_add_f32 v[38:39], v[136:137], v[138:139]
    v_pk_add_f32 v[16:17], v[60:61], v[62:63]
    v_pk_add_f32 v[28:29], v[122:123], v[124:125]
    v_pk_add_f32 v[40:41], v[142:143], v[144:145]
    v_pk_add_f32 v[18:19], v[64:65], v[66:67]
    v_pk_add_f32 v[30:31], v[126:127], v[128:129]
    v_pk_add_f32 v[42:43], v[146:147], v[148:149]
    v_add_f32 v10, v12, v13
    v_add_f32 v154, v24, v25
    v_add_f32 v160, v36, v37
    v_add_f32 v11, v14, v15
    v_add_f32 v155, v26, v27
    v_add_f32 v161, v38, v39
    v_add_f32 v70, v16, v17
    v_add_f32 v156, v28, v29
    v_add_f32 v162, v40, v41
    v_add_f32 v71, v18, v19
    v_add_f32 v157, v30, v31
    v_add_f32 v163, v42, v43
    v_pk_add_f32 v[10:11], v[10:11], v[58:59]
    v_pk_add_f32 v[154:155], v[154:155], v[120:121]
    v_pk_add_f32 v[160:161], v[160:161], v[140:141]
    v_pk_add_f32 v[70:71], v[70:71], v[68:69]
    v_pk_add_f32 v[156:157], v[156:157], v[130:131]
    v_pk_add_f32 v[162:163], v[162:163], v[150:151]
    v_permlane16_swap_b32 v10, v70
    v_permlane16_swap_b32 v154, v156
    v_permlane16_swap_b32 v160, v162
    v_permlane16_swap_b32 v11, v71
    v_permlane16_swap_b32 v155, v157
    v_permlane16_swap_b32 v161, v163
    v_add_f32 v10, v10, v70
    v_add_f32 v154, v154, v156
    v_add_f32 v160, v160, v162
    v_add_f32 v11, v11, v71
    v_add_f32 v155, v155, v157
    v_add_f32 v161, v161, v163
    v_permlane32_swap_b32 v10, v11
    v_permlane32_swap_b32 v154, v155
    v_permlane32_swap_b32 v160, v161
    v_add_f32 v152, v10, v11
    v_add_f32 v158, v154, v155
    v_add_f32 v164, v160, v161
    v_rcp_f32 v152, v152
    v_rcp_f32 v158, v158
    v_rcp_f32 v164, v164
    v_mov_b32 v153, v152
    v_mov_b32 v159, v158
    v_mov_b32 v165, v164
    v_permlane32_swap_b32 v152, v153
    v_permlane32_swap_b32 v158, v159
    v_permlane32_swap_b32 v164, v165
    v_mov_b32 v10, v152
    v_mov_b32 v154, v158
    v_mov_b32 v160, v164
    v_mov_b32 v11, v153
    v_mov_b32 v155, v159
    v_mov_b32 v161, v165
    v_permlane16_swap_b32 v10, v152
    v_permlane16_swap_b32 v154, v158
    v_permlane16_swap_b32 v160, v164
    v_permlane16_swap_b32 v11, v153
    v_permlane16_swap_b32 v155, v159
    v_permlane16_swap_b32 v161, v165
    v_pk_mul_f32 v[50:51], v[50:51], v[10:11] op_sel:[0,0] op_sel_hi:[1,0]
    v_pk_mul_f32 v[112:113], v[112:113], v[154:155] op_sel:[0,0] op_sel_hi:[1,0]
    v_pk_mul_f32 v[132:133], v[132:133], v[160:161] op_sel:[0,0] op_sel_hi:[1,0]
    v_pk_mul_f32 v[60:61], v[60:61], v[152:153] op_sel:[0,0] op_sel_hi:[1,0]
    v_pk_mul_f32 v[122:123], v[122:123], v[158:159] op_sel:[0,0] op_sel_hi:[1,0]
    v_pk_mul_f32 v[142:143], v[142:143], v[164:165] op_sel:[0,0] op_sel_hi:[1,0]
    v_pk_mul_f32 v[52:53], v[52:53], v[10:11] op_sel:[0,0] op_sel_hi:[1,0]
    v_pk_mul_f32 v[114:115], v[114:115], v[154:155] op_sel:[0,0] op_sel_hi:[1,0]
    v_pk_mul_f32 v[134:135], v[134:135], v[160:161] op_sel:[0,0] op_sel_hi:[1,0]
    v_pk_mul_f32 v[62:63], v[62:63], v[152:153] op_sel:[0,0] op_sel_hi:[1,0]
    v_pk_mul_f32 v[124:125], v[124:125], v[158:159] op_sel:[0,0] op_sel_hi:[1,0]
    v_pk_mul_f32 v[144:145], v[144:145], v[164:165] op_sel:[0,0] op_sel_hi:[1,0]
    v_mul_f32 v54, v54, v11
    v_mul_f32 v116, v116, v155
    v_mul_f32 v136, v136, v161
    v_mul_f32 v55, v55, v11
    v_mul_f32 v117, v117, v155
    v_mul_f32 v137, v137, v161
    v_mul_f32 v64, v64, v153
    v_mul_f32 v126, v126, v159
    v_mul_f32 v146, v146, v165
    v_mul_f32 v65, v65, v153
    v_mul_f32 v127, v127, v159
    v_mul_f32 v147, v147, v165
    v_mul_f32 v56, v56, v11
    v_mul_f32 v118, v118, v155
    v_mul_f32 v138, v138, v161
    v_mul_f32 v57, v57, v11
    v_mul_f32 v119, v119, v155
    v_mul_f32 v139, v139, v161
    v_mul_f32 v66, v66, v153
    v_mul_f32 v128, v128, v159
    v_mul_f32 v148, v148, v165
    v_mul_f32 v67, v67, v153
    v_mul_f32 v129, v129, v159
    v_mul_f32 v149, v149, v165
    v_pk_mul_f32 v[58:59], v[58:59], v[10:11] op_sel:[0,0] op_sel_hi:[1,1]
    v_pk_mul_f32 v[120:121], v[120:121], v[154:155] op_sel:[0,0] op_sel_hi:[1,1]
    v_pk_mul_f32 v[140:141], v[140:141], v[160:161] op_sel:[0,0] op_sel_hi:[1,1]
    v_pk_mul_f32 v[68:69], v[68:69], v[152:153] op_sel:[0,0] op_sel_hi:[1,1]
    v_pk_mul_f32 v[130:131], v[130:131], v[158:159] op_sel:[0,0] op_sel_hi:[1,1]
    v_pk_mul_f32 v[150:151], v[150:151], v[164:165] op_sel:[0,0] op_sel_hi:[1,1]
    v_cvt_pk_bf16_f32 v12, v50, v51
    v_cvt_pk_bf16_f32 v24, v112, v113
    v_cvt_pk_bf16_f32 v36, v132, v133
    v_cvt_pk_bf16_f32 v13, v52, v53
    v_cvt_pk_bf16_f32 v25, v114, v115
    v_cvt_pk_bf16_f32 v37, v134, v135
    v_cvt_pk_bf16_f32 v14, v58, v60
    v_cvt_pk_bf16_f32 v26, v120, v122
    v_cvt_pk_bf16_f32 v38, v140, v142
    v_cvt_pk_bf16_f32 v15, v61, v62
    v_cvt_pk_bf16_f32 v27, v123, v124
    v_cvt_pk_bf16_f32 v39, v143, v144
    v_cvt_pk_bf16_f32 v16, v63, v68
    v_cvt_pk_bf16_f32 v28, v125, v130
    v_cvt_pk_bf16_f32 v40, v145, v150
    v_cvt_pk_bf16_f32 v18, v54, v55
    v_cvt_pk_bf16_f32 v30, v116, v117
    v_cvt_pk_bf16_f32 v42, v136, v137
    v_cvt_pk_bf16_f32 v19, v56, v57
    v_cvt_pk_bf16_f32 v31, v118, v119
    v_cvt_pk_bf16_f32 v43, v138, v139
    v_cvt_pk_bf16_f32 v20, v59, v64
    v_cvt_pk_bf16_f32 v32, v121, v126
    v_cvt_pk_bf16_f32 v44, v141, v146
    v_cvt_pk_bf16_f32 v21, v65, v66
    v_cvt_pk_bf16_f32 v33, v127, v128
    v_cvt_pk_bf16_f32 v45, v147, v148
    v_cvt_pk_bf16_f32 v22, v67, v69
    v_cvt_pk_bf16_f32 v34, v129, v131
    v_cvt_pk_bf16_f32 v46, v149, v151
    ds_write_b64 v9, v[12:13] offset:0
    ds_write_b64 v9, v[24:25] offset:4736
    ds_write_b64 v9, v[36:37] offset:9472
    ds_write_b64 v9, v[14:15] offset:8
    ds_write_b64 v9, v[26:27] offset:4744
    ds_write_b64 v9, v[38:39] offset:9480
    ds_write_b32 v9, v16 offset:16
    ds_write_b32 v9, v28 offset:4752
    ds_write_b32 v9, v40 offset:9488
    ds_write_b64 v9, v[18:19] offset:96
    ds_write_b64 v9, v[30:31] offset:4832
    ds_write_b64 v9, v[42:43] offset:9568
    ds_write_b64 v9, v[20:21] offset:104
    ds_write_b64 v9, v[32:33] offset:4840
    ds_write_b64 v9, v[44:45] offset:9576
    ds_write_b32 v9, v22 offset:112
    ds_write_b32 v9, v34 offset:4848
    ds_write_b32 v9, v46 offset:9584
    s_waitcnt lgkmcnt(0)
    s_barrier
    s_and_b32 s95, s38, 1
    s_lshr_b32 s96, s38, 1
    v_lshrrev_b32 v4, 2, v2
    v_lshl_add_u32 v4, v3, 3, v4
    v_mul_u32_u24 v4, 296, v4
    v_add_u32 v4, 81920, v4
    v_and_b32 v5, 3, v2
    v_mul_u32_u24 v6, 24, v5
    s_mul_i32 s60, s95, 96
    v_add3_u32 v8, v4, v6, s60
    s_mul_i32 s60, s95, 40
    v_lshlrev_b32 v6, 3, v5
    v_add_u32 v6, s60, v6
    v_add_u32 v9, 192, v6
    s_add_u32 s60, s60, 224
    v_mov_b32 v6, 272
    v_mov_b32 v7, s60
    v_cmp_eq_u32 vcc, s95, v5
    s_nop 1
    v_cndmask_b32 v6, v6, v7, vcc
    s_cmp_eq_u32 s96, 0
    s_cselect_b64 vcc, -1, 0
    v_cndmask_b32 v6, v6, v9, vcc
    v_add_u32 v9, v4, v6
    ds_read_b64_tr_b16 v[24:25], v9 offset:0
    ds_read_b64_tr_b16 v[26:27], v9 offset:1184
    ds_read_b64_tr_b16 v[12:13], v8 offset:0
    ds_read_b64_tr_b16 v[14:15], v8 offset:1184
    ds_read_b64_tr_b16 v[16:17], v8 offset:8
    ds_read_b64_tr_b16 v[18:19], v8 offset:1192
    ds_read_b64_tr_b16 v[20:21], v8 offset:16
    ds_read_b64_tr_b16 v[22:23], v8 offset:1200
    ds_read_b64_tr_b16 v[40:41], v9 offset:9472
    ds_read_b64_tr_b16 v[42:43], v9 offset:10656
    ds_read_b64_tr_b16 v[28:29], v8 offset:9472
    ds_read_b64_tr_b16 v[30:31], v8 offset:10656
    ds_read_b64_tr_b16 v[32:33], v8 offset:9480
    ds_read_b64_tr_b16 v[34:35], v8 offset:10664
    ds_read_b64_tr_b16 v[36:37], v8 offset:9488
    ds_read_b64_tr_b16 v[38:39], v8 offset:10672
    s_lshl_b32 s60, s35, 4
    s_add_u32 s60, s60, s36
    s_mul_i32 s60, s60, 5120
    s_mul_i32 s61, s38, 1280
    s_add_u32 s60, s60, s61
    s_add_u32 s60, s60, 65536
    v_lshl_add_u32 v10, v1, 4, s60
    s_add_u32 s60, s60, 1024
    v_lshl_add_u32 v11, v1, 2, s60
    s_waitcnt lgkmcnt(8)
    v_mfma_f32_16x16x32_bf16 v[60:63], v[12:15], v[24:27], 0
    v_mfma_f32_16x16x32_bf16 v[64:67], v[16:19], v[24:27], 0
    v_mfma_f32_16x16x32_bf16 v[68:71], v[20:23], v[24:27], 0
    ds_read_b64_tr_b16 v[56:57], v9 offset:18944
    ds_read_b64_tr_b16 v[58:59], v9 offset:20128
    ds_read_b64_tr_b16 v[44:45], v8 offset:18944
    ds_read_b64_tr_b16 v[46:47], v8 offset:20128
    ds_read_b64_tr_b16 v[48:49], v8 offset:18952
    ds_read_b64_tr_b16 v[50:51], v8 offset:20136
    ds_read_b64_tr_b16 v[52:53], v8 offset:18960
    ds_read_b64_tr_b16 v[54:55], v8 offset:20144
    s_waitcnt lgkmcnt(8)
    v_mfma_f32_16x16x32_bf16 v[60:63], v[28:31], v[40:43], v[60:63]
    v_mfma_f32_16x16x32_bf16 v[64:67], v[32:35], v[40:43], v[64:67]
    v_mfma_f32_16x16x32_bf16 v[68:71], v[36:39], v[40:43], v[68:71]
    ds_read_b64_tr_b16 v[24:25], v9 offset:28416
    ds_read_b64_tr_b16 v[26:27], v9 offset:29600
    ds_read_b64_tr_b16 v[12:13], v8 offset:28416
    ds_read_b64_tr_b16 v[14:15], v8 offset:29600
    ds_read_b64_tr_b16 v[16:17], v8 offset:28424
    ds_read_b64_tr_b16 v[18:19], v8 offset:29608
    ds_read_b64_tr_b16 v[20:21], v8 offset:28432
    ds_read_b64_tr_b16 v[22:23], v8 offset:29616
    s_waitcnt lgkmcnt(8)
    v_mfma_f32_16x16x32_bf16 v[60:63], v[44:47], v[56:59], v[60:63]
    v_mfma_f32_16x16x32_bf16 v[64:67], v[48:51], v[56:59], v[64:67]
    v_mfma_f32_16x16x32_bf16 v[68:71], v[52:55], v[56:59], v[68:71]
    ds_read_b64_tr_b16 v[40:41], v9 offset:37888
    ds_read_b64_tr_b16 v[42:43], v9 offset:39072
    ds_read_b64_tr_b16 v[28:29], v8 offset:37888
    ds_read_b64_tr_b16 v[30:31], v8 offset:39072
    ds_read_b64_tr_b16 v[32:33], v8 offset:37896
    ds_read_b64_tr_b16 v[34:35], v8 offset:39080
    ds_read_b64_tr_b16 v[36:37], v8 offset:37904
    ds_read_b64_tr_b16 v[38:39], v8 offset:39088
    s_waitcnt lgkmcnt(8)
    v_mfma_f32_16x16x32_bf16 v[60:63], v[12:15], v[24:27], v[60:63]
    v_mfma_f32_16x16x32_bf16 v[64:67], v[16:19], v[24:27], v[64:67]
    v_mfma_f32_16x16x32_bf16 v[68:71], v[20:23], v[24:27], v[68:71]
    ds_read_b64_tr_b16 v[56:57], v9 offset:47360
    ds_read_b64_tr_b16 v[58:59], v9 offset:48544
    ds_read_b64_tr_b16 v[44:45], v8 offset:47360
    ds_read_b64_tr_b16 v[46:47], v8 offset:48544
    ds_read_b64_tr_b16 v[48:49], v8 offset:47368
    ds_read_b64_tr_b16 v[50:51], v8 offset:48552
    ds_read_b64_tr_b16 v[52:53], v8 offset:47376
    ds_read_b64_tr_b16 v[54:55], v8 offset:48560
    s_waitcnt lgkmcnt(8)
    v_mfma_f32_16x16x32_bf16 v[60:63], v[28:31], v[40:43], v[60:63]
    v_mfma_f32_16x16x32_bf16 v[64:67], v[32:35], v[40:43], v[64:67]
    v_mfma_f32_16x16x32_bf16 v[68:71], v[36:39], v[40:43], v[68:71]
    s_waitcnt lgkmcnt(0)
    v_mfma_f32_16x16x32_bf16 v[60:63], v[44:47], v[56:59], v[60:63]
    v_mfma_f32_16x16x32_bf16 v[64:67], v[48:51], v[56:59], v[64:67]
    v_mfma_f32_16x16x32_bf16 v[68:71], v[52:55], v[56:59], v[68:71]
    s_nop 5
    v_cvt_pk_bf16_f32 v72, v60, v61
    v_cvt_pk_bf16_f32 v73, v62, v63
    v_cvt_pk_bf16_f32 v74, v64, v65
    v_cvt_pk_bf16_f32 v75, v66, v67
    v_cvt_pk_bf16_f32 v76, v68, v69
    buffer_store_dwordx4 v[72:75], v10, s[48:51], 0 offen sc1
    buffer_store_dword v76, v11, s[48:51], 0 offen sc1
    s_lshl_b32 s60, s35, 4
    s_add_u32 s60, s60, s36
    s_sub_u32 s60, s60, s80
    s_mul_i32 s60, s60, 5120
    v_subrev_u32 v4, s60, v10
    v_subrev_u32 v5, s60, v11
    s_mov_b32 s101, 0
    s_mov_b32 s97, 0x3f800000
    s_mov_b32 s90, 0x00003f80
    s_waitcnt vmcnt(0)
    s_mov_b32 s60, 0
    buffer_load_dwordx4 v[12:15], v4, s[48:51], s60 offen sc1
    buffer_load_dword v56, v5, s[48:51], s60 offen sc1
    s_mov_b32 s60, 81920
    buffer_load_dwordx4 v[16:19], v4, s[48:51], s60 offen sc1
    buffer_load_dword v57, v5, s[48:51], s60 offen sc1
    s_mov_b32 s60, 163840
    buffer_load_dwordx4 v[20:23], v4, s[48:51], s60 offen sc1
    buffer_load_dword v58, v5, s[48:51], s60 offen sc1
    s_mov_b32 s60, 245760
    buffer_load_dwordx4 v[24:27], v4, s[48:51], s60 offen sc1
    buffer_load_dword v59, v5, s[48:51], s60 offen sc1
    s_mov_b32 s60, 327680
    buffer_load_dwordx4 v[28:31], v4, s[48:51], s60 offen sc1
    buffer_load_dword v60, v5, s[48:51], s60 offen sc1
    s_mov_b32 s60, 409600
    buffer_load_dwordx4 v[32:35], v4, s[48:51], s60 offen sc1
    buffer_load_dword v61, v5, s[48:51], s60 offen sc1
    s_mov_b32 s60, 491520
    buffer_load_dwordx4 v[36:39], v4, s[48:51], s60 offen sc1
    buffer_load_dword v62, v5, s[48:51], s60 offen sc1
    s_mov_b32 s60, 573440
    buffer_load_dwordx4 v[40:43], v4, s[48:51], s60 offen sc1
    buffer_load_dword v63, v5, s[48:51], s60 offen sc1
    s_mov_b32 s60, 655360
    buffer_load_dwordx4 v[44:47], v4, s[48:51], s60 offen sc1
    buffer_load_dword v64, v5, s[48:51], s60 offen sc1
    s_mov_b32 s60, 737280
    buffer_load_dwordx4 v[48:51], v4, s[48:51], s60 offen sc1
    buffer_load_dword v65, v5, s[48:51], s60 offen sc1
    s_mov_b32 s60, 819200
    buffer_load_dwordx4 v[52:55], v4, s[48:51], s60 offen sc1
    buffer_load_dword v66, v5, s[48:51], s60 offen sc1
L_b_att1:
    s_waitcnt vmcnt(0)
    s_mov_b32 s91, 0
    v_max3_u32 v68, v12, v13, v14
    v_max3_u32 v68, v68, v15, v56
    v_cmp_eq_u32 vcc, -1, v68
    s_cbranch_vccz L_b_have1_0
    s_mov_b32 s91, 1
    s_mov_b32 s60, 0
    buffer_load_dwordx4 v[12:15], v4, s[48:51], s60 offen sc1
    buffer_load_dword v56, v5, s[48:51], s60 offen sc1
L_b_have1_0:
    v_max3_u32 v68, v16, v17, v18
    v_max3_u32 v68, v68, v19, v57
    v_cmp_eq_u32 vcc, -1, v68
    s_cbranch_vccz L_b_have1_1
    s_mov_b32 s91, 1
    s_mov_b32 s60, 81920
    buffer_load_dwordx4 v[16:19], v4, s[48:51], s60 offen sc1
    buffer_load_dword v57, v5, s[48:51], s60 offen sc1
L_b_have1_1:
    v_max3_u32 v68, v20, v21, v22
    v_max3_u32 v68, v68, v23, v58
    v_cmp_eq_u32 vcc, -1, v68
    s_cbranch_vccz L_b_have1_2
    s_mov_b32 s91, 1
    s_mov_b32 s60, 163840
    buffer_load_dwordx4 v[20:23], v4, s[48:51], s60 offen sc1
    buffer_load_dword v58, v5, s[48:51], s60 offen sc1
L_b_have1_2:
    v_max3_u32 v68, v24, v25, v26
    v_max3_u32 v68, v68, v27, v59
    v_cmp_eq_u32 vcc, -1, v68
    s_cbranch_vccz L_b_have1_3
    s_mov_b32 s91, 1
    s_mov_b32 s60, 245760
    buffer_load_dwordx4 v[24:27], v4, s[48:51], s60 offen sc1
    buffer_load_dword v59, v5, s[48:51], s60 offen sc1
L_b_have1_3:
    v_max3_u32 v68, v28, v29, v30
    v_max3_u32 v68, v68, v31, v60
    v_cmp_eq_u32 vcc, -1, v68
    s_cbranch_vccz L_b_have1_4
    s_mov_b32 s91, 1
    s_mov_b32 s60, 327680
    buffer_load_dwordx4 v[28:31], v4, s[48:51], s60 offen sc1
    buffer_load_dword v60, v5, s[48:51], s60 offen sc1
L_b_have1_4:
    v_max3_u32 v68, v32, v33, v34
    v_max3_u32 v68, v68, v35, v61
    v_cmp_eq_u32 vcc, -1, v68
    s_cbranch_vccz L_b_have1_5
    s_mov_b32 s91, 1
    s_mov_b32 s60, 409600
    buffer_load_dwordx4 v[32:35], v4, s[48:51], s60 offen sc1
    buffer_load_dword v61, v5, s[48:51], s60 offen sc1
L_b_have1_5:
    v_max3_u32 v68, v36, v37, v38
    v_max3_u32 v68, v68, v39, v62
    v_cmp_eq_u32 vcc, -1, v68
    s_cbranch_vccz L_b_have1_6
    s_mov_b32 s91, 1
    s_mov_b32 s60, 491520
    buffer_load_dwordx4 v[36:39], v4, s[48:51], s60 offen sc1
    buffer_load_dword v62, v5, s[48:51], s60 offen sc1
L_b_have1_6:
    v_max3_u32 v68, v40, v41, v42
    v_max3_u32 v68, v68, v43, v63
    v_cmp_eq_u32 vcc, -1, v68
    s_cbranch_vccz L_b_have1_7
    s_mov_b32 s91, 1
    s_mov_b32 s60, 573440
    buffer_load_dwordx4 v[40:43], v4, s[48:51], s60 offen sc1
    buffer_load_dword v63, v5, s[48:51], s60 offen sc1
L_b_have1_7:
    v_max3_u32 v68, v44, v45, v46
    v_max3_u32 v68, v68, v47, v64
    v_cmp_eq_u32 vcc, -1, v68
    s_cbranch_vccz L_b_have1_8
    s_mov_b32 s91, 1
    s_mov_b32 s60, 655360
    buffer_load_dwordx4 v[44:47], v4, s[48:51], s60 offen sc1
    buffer_load_dword v64, v5, s[48:51], s60 offen sc1
L_b_have1_8:
    v_max3_u32 v68, v48, v49, v50
    v_max3_u32 v68, v68, v51, v65
    v_cmp_eq_u32 vcc, -1, v68
    s_cbranch_vccz L_b_have1_9
    s_mov_b32 s91, 1
    s_mov_b32 s60, 737280
    buffer_load_dwordx4 v[48:51], v4, s[48:51], s60 offen sc1
    buffer_load_dword v65, v5, s[48:51], s60 offen sc1
L_b_have1_9:
    v_max3_u32 v68, v52, v53, v54
    v_max3_u32 v68, v68, v55, v66
    v_cmp_eq_u32 vcc, -1, v68
    s_cbranch_vccz L_b_have1_10
    s_mov_b32 s91, 1
    s_mov_b32 s60, 819200
    buffer_load_dwordx4 v[52:55], v4, s[48:51], s60 offen sc1
    buffer_load_dword v66, v5, s[48:51], s60 offen sc1
L_b_have1_10:
    s_cmp_eq_u32 s91, 0
    s_cbranch_scc1 L_b_got1
    s_add_u32 s101, s101, 1
    s_cmp_le_u32 s101, 16384
    s_cbranch_scc1 L_b_att1
    s_waitcnt vmcnt(0)
L_b_got1:
    v_dot2_f32_bf16 v78, v12, s90, 0
    v_dot2_f32_bf16 v79, v12, s97, 0
    v_dot2_f32_bf16 v80, v13, s90, 0
    v_dot2_f32_bf16 v81, v13, s97, 0
    v_dot2_f32_bf16 v82, v14, s90, 0
    v_dot2_f32_bf16 v83, v14, s97, 0
    v_dot2_f32_bf16 v84, v15, s90, 0
    v_dot2_f32_bf16 v85, v15, s97, 0
    v_dot2_f32_bf16 v86, v56, s90, 0
    v_dot2_f32_bf16 v87, v56, s97, 0
    v_dot2_f32_bf16 v78, v16, s90, v78
    v_dot2_f32_bf16 v79, v16, s97, v79
    v_dot2_f32_bf16 v80, v17, s90, v80
    v_dot2_f32_bf16 v81, v17, s97, v81
    v_dot2_f32_bf16 v82, v18, s90, v82
    v_dot2_f32_bf16 v83, v18, s97, v83
    v_dot2_f32_bf16 v84, v19, s90, v84
    v_dot2_f32_bf16 v85, v19, s97, v85
    v_dot2_f32_bf16 v86, v57, s90, v86
    v_dot2_f32_bf16 v87, v57, s97, v87
    v_dot2_f32_bf16 v78, v20, s90, v78
    v_dot2_f32_bf16 v79, v20, s97, v79
    v_dot2_f32_bf16 v80, v21, s90, v80
    v_dot2_f32_bf16 v81, v21, s97, v81
    v_dot2_f32_bf16 v82, v22, s90, v82
    v_dot2_f32_bf16 v83, v22, s97, v83
    v_dot2_f32_bf16 v84, v23, s90, v84
    v_dot2_f32_bf16 v85, v23, s97, v85
    v_dot2_f32_bf16 v86, v58, s90, v86
    v_dot2_f32_bf16 v87, v58, s97, v87
    v_dot2_f32_bf16 v78, v24, s90, v78
    v_dot2_f32_bf16 v79, v24, s97, v79
    v_dot2_f32_bf16 v80, v25, s90, v80
    v_dot2_f32_bf16 v81, v25, s97, v81
    v_dot2_f32_bf16 v82, v26, s90, v82
    v_dot2_f32_bf16 v83, v26, s97, v83
    v_dot2_f32_bf16 v84, v27, s90, v84
    v_dot2_f32_bf16 v85, v27, s97, v85
    v_dot2_f32_bf16 v86, v59, s90, v86
    v_dot2_f32_bf16 v87, v59, s97, v87
    v_dot2_f32_bf16 v78, v28, s90, v78
    v_dot2_f32_bf16 v79, v28, s97, v79
    v_dot2_f32_bf16 v80, v29, s90, v80
    v_dot2_f32_bf16 v81, v29, s97, v81
    v_dot2_f32_bf16 v82, v30, s90, v82
    v_dot2_f32_bf16 v83, v30, s97, v83
    v_dot2_f32_bf16 v84, v31, s90, v84
    v_dot2_f32_bf16 v85, v31, s97, v85
    v_dot2_f32_bf16 v86, v60, s90, v86
    v_dot2_f32_bf16 v87, v60, s97, v87
    v_dot2_f32_bf16 v78, v32, s90, v78
    v_dot2_f32_bf16 v79, v32, s97, v79
    v_dot2_f32_bf16 v80, v33, s90, v80
    v_dot2_f32_bf16 v81, v33, s97, v81
    v_dot2_f32_bf16 v82, v34, s90, v82
    v_dot2_f32_bf16 v83, v34, s97, v83
    v_dot2_f32_bf16 v84, v35, s90, v84
    v_dot2_f32_bf16 v85, v35, s97, v85
    v_dot2_f32_bf16 v86, v61, s90, v86
    v_dot2_f32_bf16 v87, v61, s97, v87
    v_dot2_f32_bf16 v78, v36, s90, v78
    v_dot2_f32_bf16 v79, v36, s97, v79
    v_dot2_f32_bf16 v80, v37, s90, v80
    v_dot2_f32_bf16 v81, v37, s97, v81
    v_dot2_f32_bf16 v82, v38, s90, v82
    v_dot2_f32_bf16 v83, v38, s97, v83
    v_dot2_f32_bf16 v84, v39, s90, v84
    v_dot2_f32_bf16 v85, v39, s97, v85
    v_dot2_f32_bf16 v86, v62, s90, v86
    v_dot2_f32_bf16 v87, v62, s97, v87
    v_dot2_f32_bf16 v78, v40, s90, v78
    v_dot2_f32_bf16 v79, v40, s97, v79
    v_dot2_f32_bf16 v80, v41, s90, v80
    v_dot2_f32_bf16 v81, v41, s97, v81
    v_dot2_f32_bf16 v82, v42, s90, v82
    v_dot2_f32_bf16 v83, v42, s97, v83
    v_dot2_f32_bf16 v84, v43, s90, v84
    v_dot2_f32_bf16 v85, v43, s97, v85
    v_dot2_f32_bf16 v86, v63, s90, v86
    v_dot2_f32_bf16 v87, v63, s97, v87
    v_dot2_f32_bf16 v78, v44, s90, v78
    v_dot2_f32_bf16 v79, v44, s97, v79
    v_dot2_f32_bf16 v80, v45, s90, v80
    v_dot2_f32_bf16 v81, v45, s97, v81
    v_dot2_f32_bf16 v82, v46, s90, v82
    v_dot2_f32_bf16 v83, v46, s97, v83
    v_dot2_f32_bf16 v84, v47, s90, v84
    v_dot2_f32_bf16 v85, v47, s97, v85
    v_dot2_f32_bf16 v86, v64, s90, v86
    v_dot2_f32_bf16 v87, v64, s97, v87
    v_dot2_f32_bf16 v78, v48, s90, v78
    v_dot2_f32_bf16 v79, v48, s97, v79
    v_dot2_f32_bf16 v80, v49, s90, v80
    v_dot2_f32_bf16 v81, v49, s97, v81
    v_dot2_f32_bf16 v82, v50, s90, v82
    v_dot2_f32_bf16 v83, v50, s97, v83
    v_dot2_f32_bf16 v84, v51, s90, v84
    v_dot2_f32_bf16 v85, v51, s97, v85
    v_dot2_f32_bf16 v86, v65, s90, v86
    v_dot2_f32_bf16 v87, v65, s97, v87
    v_dot2_f32_bf16 v78, v52, s90, v78
    v_dot2_f32_bf16 v79, v52, s97, v79
    v_dot2_f32_bf16 v80, v53, s90, v80
    v_dot2_f32_bf16 v81, v53, s97, v81
    v_dot2_f32_bf16 v82, v54, s90, v82
    v_dot2_f32_bf16 v83, v54, s97, v83
    v_dot2_f32_bf16 v84, v55, s90, v84
    v_dot2_f32_bf16 v85, v55, s97, v85
    v_dot2_f32_bf16 v86, v66, s90, v86
    v_dot2_f32_bf16 v87, v66, s97, v87
L_b_sum1:
    v_cvt_pk_bf16_f32 v12, v78, v79
    v_cvt_pk_bf16_f32 v13, v80, v81
    v_cvt_pk_bf16_f32 v14, v82, v83
    v_cvt_pk_bf16_f32 v15, v84, v85
    v_cvt_pk_bf16_f32 v16, v86, v87
    s_lshl_b32 s61, s38, 10
    s_add_u32 s61, s61, 139264
    v_lshl_add_u32 v4, v1, 4, s61
    ds_write_b128 v4, v[12:15]
    s_lshl_b32 s61, s38, 8
    s_add_u32 s61, s61, 143360
    v_lshl_add_u32 v5, v1, 2, s61
    ds_write_b32 v5, v16
    s_waitcnt lgkmcnt(0)
    s_barrier
    s_barrier
    s_branch L_b_final
L_b_qtype:
    s_waitcnt lgkmcnt(0)
    s_barrier
    v_mfma_f32_16x16x32_bf16 v[12:15], v[72:75], v[88:91], 0
    v_mfma_f32_16x16x32_bf16 v[24:27], v[72:75], v[96:99], 0
    v_mfma_f32_16x16x32_bf16 v[36:39], v[72:75], v[104:107], 0
    v_mfma_f32_16x16x32_bf16 v[20:23], v[80:83], v[88:91], 0
    v_mfma_f32_16x16x32_bf16 v[32:35], v[80:83], v[96:99], 0
    v_mfma_f32_16x16x32_bf16 v[44:47], v[80:83], v[104:107], 0
    v_mfma_f32_16x16x32_bf16 v[16:19], v[76:79], v[90:93], 0
    v_mfma_f32_16x16x32_bf16 v[28:31], v[76:79], v[98:101], 0
    v_mfma_f32_16x16x32_bf16 v[40:43], v[76:79], v[106:109], 0
    v_mfma_f32_16x16x32_bf16 v[20:23], v[84:87], v[90:93], v[20:23]
    v_mfma_f32_16x16x32_bf16 v[32:35], v[84:87], v[98:101], v[32:35]
    v_mfma_f32_16x16x32_bf16 v[44:47], v[84:87], v[106:109], v[44:47]
    v_max3_f32 v10, v12, v13, v14
    v_max3_f32 v154, v24, v25, v26
    v_max3_f32 v160, v36, v37, v38
    v_max3_f32 v70, -v12, -v13, -v14
    v_max3_f32 v156, -v24, -v25, -v26
    v_max3_f32 v162, -v36, -v37, -v38
    v_max3_f32 v11, v16, v17, v18
    v_max3_f32 v155, v28, v29, v30
    v_max3_f32 v161, v40, v41, v42
    v_max3_f32 v71, -v16, -v17, -v18
    v_max3_f32 v157, -v28, -v29, -v30
    v_max3_f32 v163, -v40, -v41, -v42
    v_max3_f32 v10, v10, v15, v20
    v_max3_f32 v154, v154, v27, v32
    v_max3_f32 v160, v160, v39, v44
    v_max3_f32 v70, v70, -v15, -v20
    v_max3_f32 v156, v156, -v27, -v32
    v_max3_f32 v162, v162, -v39, -v44
    v_max3_f32 v11, v11, v19, v21
    v_max3_f32 v155, v155, v31, v33
    v_max3_f32 v161, v161, v43, v45
    v_max3_f32 v71, v71, -v19, -v21
    v_max3_f32 v157, v157, -v31, -v33
    v_max3_f32 v163, v163, -v43, -v45
    v_permlane16_swap_b32 v10, v70
    v_permlane16_swap_b32 v154, v156
    v_permlane16_swap_b32 v160, v162
    v_permlane16_swap_b32 v11, v71
    v_permlane16_swap_b32 v155, v157
    v_permlane16_swap_b32 v161, v163
    v_max_f32 v10, v10, v70
    v_max_f32 v154, v154, v156
    v_max_f32 v160, v160, v162
    v_max_f32 v11, v11, v71
    v_max_f32 v155, v155, v157
    v_max_f32 v161, v161, v163
    v_permlane32_swap_b32 v10, v11
    v_permlane32_swap_b32 v154, v155
    v_permlane32_swap_b32 v160, v161
    v_max_f32 v152, v10, v11
    v_max_f32 v158, v154, v155
    v_max_f32 v164, v160, v161
    v_mul_f32 v152, s88, v152
    v_mul_f32 v158, s88, v158
    v_mul_f32 v164, s88, v164
    v_mov_b32 v153, v152
    v_mov_b32 v159, v158
    v_mov_b32 v165, v164
    v_permlane32_swap_b32 v152, v153
    v_permlane32_swap_b32 v158, v159
    v_permlane32_swap_b32 v164, v165
    v_mov_b32 v10, v152
    v_mov_b32 v154, v158
    v_mov_b32 v160, v164
    v_mov_b32 v11, v153
    v_mov_b32 v155, v159
    v_mov_b32 v161, v165
    v_permlane16_swap_b32 v10, v152
    v_permlane16_swap_b32 v154, v158
    v_permlane16_swap_b32 v160, v164
    v_permlane16_swap_b32 v11, v153
    v_permlane16_swap_b32 v155, v159
    v_permlane16_swap_b32 v161, v165
    v_pk_fma_f32 v[50:51], v[12:13], s[88:89], v[10:11] op_sel:[0,0,0] op_sel_hi:[1,1,0] neg_lo:[0,0,1] neg_hi:[0,0,1]
    v_pk_fma_f32 v[112:113], v[24:25], s[88:89], v[154:155] op_sel:[0,0,0] op_sel_hi:[1,1,0] neg_lo:[0,0,1] neg_hi:[0,0,1]
    v_pk_fma_f32 v[132:133], v[36:37], s[88:89], v[160:161] op_sel:[0,0,0] op_sel_hi:[1,1,0] neg_lo:[0,0,1] neg_hi:[0,0,1]
    v_pk_fma_f32 v[60:61], v[12:13], s[88:89], v[152:153] op_sel:[0,0,0] op_sel_hi:[1,1,0] neg_lo:[1,0,1] neg_hi:[1,0,1]
    v_pk_fma_f32 v[122:123], v[24:25], s[88:89], v[158:159] op_sel:[0,0,0] op_sel_hi:[1,1,0] neg_lo:[1,0,1] neg_hi:[1,0,1]
    v_pk_fma_f32 v[142:143], v[36:37], s[88:89], v[164:165] op_sel:[0,0,0] op_sel_hi:[1,1,0] neg_lo:[1,0,1] neg_hi:[1,0,1]
    v_pk_fma_f32 v[52:53], v[14:15], s[88:89], v[10:11] op_sel:[0,0,0] op_sel_hi:[1,1,0] neg_lo:[0,0,1] neg_hi:[0,0,1]
    v_pk_fma_f32 v[114:115], v[26:27], s[88:89], v[154:155] op_sel:[0,0,0] op_sel_hi:[1,1,0] neg_lo:[0,0,1] neg_hi:[0,0,1]
    v_pk_fma_f32 v[134:135], v[38:39], s[88:89], v[160:161] op_sel:[0,0,0] op_sel_hi:[1,1,0] neg_lo:[0,0,1] neg_hi:[0,0,1]
    v_pk_fma_f32 v[62:63], v[14:15], s[88:89], v[152:153] op_sel:[0,0,0] op_sel_hi:[1,1,0] neg_lo:[1,0,1] neg_hi:[1,0,1]
    v_pk_fma_f32 v[124:125], v[26:27], s[88:89], v[158:159] op_sel:[0,0,0] op_sel_hi:[1,1,0] neg_lo:[1,0,1] neg_hi:[1,0,1]
    v_pk_fma_f32 v[144:145], v[38:39], s[88:89], v[164:165] op_sel:[0,0,0] op_sel_hi:[1,1,0] neg_lo:[1,0,1] neg_hi:[1,0,1]
    v_fma_f32 v54, v16, s88, -v11
    v_fma_f32 v116, v28, s88, -v155
    v_fma_f32 v136, v40, s88, -v161
    v_fma_f32 v55, v17, s88, -v11
    v_fma_f32 v117, v29, s88, -v155
    v_fma_f32 v137, v41, s88, -v161
    v_fma_f32 v64, -v16, s88, -v153
    v_fma_f32 v126, -v28, s88, -v159
    v_fma_f32 v146, -v40, s88, -v165
    v_fma_f32 v65, -v17, s88, -v153
    v_fma_f32 v127, -v29, s88, -v159
    v_fma_f32 v147, -v41, s88, -v165
    v_fma_f32 v56, v18, s88, -v11
    v_fma_f32 v118, v30, s88, -v155
    v_fma_f32 v138, v42, s88, -v161
    v_fma_f32 v57, v19, s88, -v11
    v_fma_f32 v119, v31, s88, -v155
    v_fma_f32 v139, v43, s88, -v161
    v_fma_f32 v66, -v18, s88, -v153
    v_fma_f32 v128, -v30, s88, -v159
    v_fma_f32 v148, -v42, s88, -v165
    v_fma_f32 v67, -v19, s88, -v153
    v_fma_f32 v129, -v31, s88, -v159
    v_fma_f32 v149, -v43, s88, -v165
    v_pk_fma_f32 v[58:59], v[20:21], s[88:89], v[10:11] op_sel:[0,0,0] op_sel_hi:[1,1,1] neg_lo:[0,0,1] neg_hi:[0,0,1]
    v_pk_fma_f32 v[120:121], v[32:33], s[88:89], v[154:155] op_sel:[0,0,0] op_sel_hi:[1,1,1] neg_lo:[0,0,1] neg_hi:[0,0,1]
    v_pk_fma_f32 v[140:141], v[44:45], s[88:89], v[160:161] op_sel:[0,0,0] op_sel_hi:[1,1,1] neg_lo:[0,0,1] neg_hi:[0,0,1]
    v_pk_fma_f32 v[68:69], v[20:21], s[88:89], v[152:153] op_sel:[0,0,0] op_sel_hi:[1,1,1] neg_lo:[1,0,1] neg_hi:[1,0,1]
    v_pk_fma_f32 v[130:131], v[32:33], s[88:89], v[158:159] op_sel:[0,0,0] op_sel_hi:[1,1,1] neg_lo:[1,0,1] neg_hi:[1,0,1]
    v_pk_fma_f32 v[150:151], v[44:45], s[88:89], v[164:165] op_sel:[0,0,0] op_sel_hi:[1,1,1] neg_lo:[1,0,1] neg_hi:[1,0,1]
    v_exp_f32 v50, v50
    v_exp_f32 v112, v112
    v_exp_f32 v132, v132
    v_exp_f32 v51, v51
    v_exp_f32 v113, v113
    v_exp_f32 v133, v133
    v_exp_f32 v52, v52
    v_exp_f32 v114, v114
    v_exp_f32 v134, v134
    v_exp_f32 v53, v53
    v_exp_f32 v115, v115
    v_exp_f32 v135, v135
    v_exp_f32 v54, v54
    v_exp_f32 v116, v116
    v_exp_f32 v136, v136
    v_exp_f32 v55, v55
    v_exp_f32 v117, v117
    v_exp_f32 v137, v137
    v_exp_f32 v56, v56
    v_exp_f32 v118, v118
    v_exp_f32 v138, v138
    v_exp_f32 v57, v57
    v_exp_f32 v119, v119
    v_exp_f32 v139, v139
    v_exp_f32 v58, v58
    v_exp_f32 v120, v120
    v_exp_f32 v140, v140
    v_exp_f32 v59, v59
    v_exp_f32 v121, v121
    v_exp_f32 v141, v141
    v_exp_f32 v60, v60
    v_exp_f32 v122, v122
    v_exp_f32 v142, v142
    v_exp_f32 v61, v61
    v_exp_f32 v123, v123
    v_exp_f32 v143, v143
    v_exp_f32 v62, v62
    v_exp_f32 v124, v124
    v_exp_f32 v144, v144
    v_exp_f32 v63, v63
    v_exp_f32 v125, v125
    v_exp_f32 v145, v145
    v_exp_f32 v64, v64
    v_exp_f32 v126, v126
    v_exp_f32 v146, v146
    v_exp_f32 v65, v65
    v_exp_f32 v127, v127
    v_exp_f32 v147, v147
    v_exp_f32 v66, v66
    v_exp_f32 v128, v128
    v_exp_f32 v148, v148
    v_exp_f32 v67, v67
    v_exp_f32 v129, v129
    v_exp_f32 v149, v149
    v_exp_f32 v68, v68
    v_exp_f32 v130, v130
    v_exp_f32 v150, v150
    v_exp_f32 v69, v69
    v_exp_f32 v131, v131
    v_exp_f32 v151, v151
    v_pk_add_f32 v[12:13], v[50:51], v[52:53]
    v_pk_add_f32 v[24:25], v[112:113], v[114:115]
    v_pk_add_f32 v[36:37], v[132:133], v[134:135]
    v_pk_add_f32 v[14:15], v[54:55], v[56:57]
    v_pk_add_f32 v[26:27], v[116:117], v[118:119]
    v_pk_add_f32 v[38:39], v[136:137], v[138:139]
    v_pk_add_f32 v[16:17], v[60:61], v[62:63]
    v_pk_add_f32 v[28:29], v[122:123], v[124:125]
    v_pk_add_f32 v[40:41], v[142:143], v[144:145]
    v_pk_add_f32 v[18:19], v[64:65], v[66:67]
    v_pk_add_f32 v[30:31], v[126:127], v[128:129]
    v_pk_add_f32 v[42:43], v[146:147], v[148:149]
    v_add_f32 v10, v12, v13
    v_add_f32 v154, v24, v25
    v_add_f32 v160, v36, v37
    v_add_f32 v11, v14, v15
    v_add_f32 v155, v26, v27
    v_add_f32 v161, v38, v39
    v_add_f32 v70, v16, v17
    v_add_f32 v156, v28, v29
    v_add_f32 v162, v40, v41
    v_add_f32 v71, v18, v19
    v_add_f32 v157, v30, v31
    v_add_f32 v163, v42, v43
    v_pk_add_f32 v[10:11], v[10:11], v[58:59]
    v_pk_add_f32 v[154:155], v[154:155], v[120:121]
    v_pk_add_f32 v[160:161], v[160:161], v[140:141]
    v_pk_add_f32 v[70:71], v[70:71], v[68:69]
    v_pk_add_f32 v[156:157], v[156:157], v[130:131]
    v_pk_add_f32 v[162:163], v[162:163], v[150:151]
    v_permlane16_swap_b32 v10, v70
    v_permlane16_swap_b32 v154, v156
    v_permlane16_swap_b32 v160, v162
    v_permlane16_swap_b32 v11, v71
    v_permlane16_swap_b32 v155, v157
    v_permlane16_swap_b32 v161, v163
    v_add_f32 v10, v10, v70
    v_add_f32 v154, v154, v156
    v_add_f32 v160, v160, v162
    v_add_f32 v11, v11, v71
    v_add_f32 v155, v155, v157
    v_add_f32 v161, v161, v163
    v_permlane32_swap_b32 v10, v11
    v_permlane32_swap_b32 v154, v155
    v_permlane32_swap_b32 v160, v161
    v_add_f32 v152, v10, v11
    v_add_f32 v158, v154, v155
    v_add_f32 v164, v160, v161
    v_rcp_f32 v152, v152
    v_rcp_f32 v158, v158
    v_rcp_f32 v164, v164
    v_mov_b32 v153, v152
    v_mov_b32 v159, v158
    v_mov_b32 v165, v164
    v_permlane32_swap_b32 v152, v153
    v_permlane32_swap_b32 v158, v159
    v_permlane32_swap_b32 v164, v165
    v_mov_b32 v10, v152
    v_mov_b32 v154, v158
    v_mov_b32 v160, v164
    v_mov_b32 v11, v153
    v_mov_b32 v155, v159
    v_mov_b32 v161, v165
    v_permlane16_swap_b32 v10, v152
    v_permlane16_swap_b32 v154, v158
    v_permlane16_swap_b32 v160, v164
    v_permlane16_swap_b32 v11, v153
    v_permlane16_swap_b32 v155, v159
    v_permlane16_swap_b32 v161, v165
    v_pk_mul_f32 v[50:51], v[50:51], v[10:11] op_sel:[0,0] op_sel_hi:[1,0]
    v_pk_mul_f32 v[112:113], v[112:113], v[154:155] op_sel:[0,0] op_sel_hi:[1,0]
    v_pk_mul_f32 v[132:133], v[132:133], v[160:161] op_sel:[0,0] op_sel_hi:[1,0]
    v_pk_mul_f32 v[60:61], v[60:61], v[152:153] op_sel:[0,0] op_sel_hi:[1,0]
    v_pk_mul_f32 v[122:123], v[122:123], v[158:159] op_sel:[0,0] op_sel_hi:[1,0]
    v_pk_mul_f32 v[142:143], v[142:143], v[164:165] op_sel:[0,0] op_sel_hi:[1,0]
    v_pk_mul_f32 v[52:53], v[52:53], v[10:11] op_sel:[0,0] op_sel_hi:[1,0]
    v_pk_mul_f32 v[114:115], v[114:115], v[154:155] op_sel:[0,0] op_sel_hi:[1,0]
    v_pk_mul_f32 v[134:135], v[134:135], v[160:161] op_sel:[0,0] op_sel_hi:[1,0]
    v_pk_mul_f32 v[62:63], v[62:63], v[152:153] op_sel:[0,0] op_sel_hi:[1,0]
    v_pk_mul_f32 v[124:125], v[124:125], v[158:159] op_sel:[0,0] op_sel_hi:[1,0]
    v_pk_mul_f32 v[144:145], v[144:145], v[164:165] op_sel:[0,0] op_sel_hi:[1,0]
    v_mul_f32 v54, v54, v11
    v_mul_f32 v116, v116, v155
    v_mul_f32 v136, v136, v161
    v_mul_f32 v55, v55, v11
    v_mul_f32 v117, v117, v155
    v_mul_f32 v137, v137, v161
    v_mul_f32 v64, v64, v153
    v_mul_f32 v126, v126, v159
    v_mul_f32 v146, v146, v165
    v_mul_f32 v65, v65, v153
    v_mul_f32 v127, v127, v159
    v_mul_f32 v147, v147, v165
    v_mul_f32 v56, v56, v11
    v_mul_f32 v118, v118, v155
    v_mul_f32 v138, v138, v161
    v_mul_f32 v57, v57, v11
    v_mul_f32 v119, v119, v155
    v_mul_f32 v139, v139, v161
    v_mul_f32 v66, v66, v153
    v_mul_f32 v128, v128, v159
    v_mul_f32 v148, v148, v165
    v_mul_f32 v67, v67, v153
    v_mul_f32 v129, v129, v159
    v_mul_f32 v149, v149, v165
    v_pk_mul_f32 v[58:59], v[58:59], v[10:11] op_sel:[0,0] op_sel_hi:[1,1]
    v_pk_mul_f32 v[120:121], v[120:121], v[154:155] op_sel:[0,0] op_sel_hi:[1,1]
    v_pk_mul_f32 v[140:141], v[140:141], v[160:161] op_sel:[0,0] op_sel_hi:[1,1]
    v_pk_mul_f32 v[68:69], v[68:69], v[152:153] op_sel:[0,0] op_sel_hi:[1,1]
    v_pk_mul_f32 v[130:131], v[130:131], v[158:159] op_sel:[0,0] op_sel_hi:[1,1]
    v_pk_mul_f32 v[150:151], v[150:151], v[164:165] op_sel:[0,0] op_sel_hi:[1,1]
    v_cvt_pk_bf16_f32 v12, v50, v51
    v_cvt_pk_bf16_f32 v24, v112, v113
    v_cvt_pk_bf16_f32 v36, v132, v133
    v_cvt_pk_bf16_f32 v13, v52, v53
    v_cvt_pk_bf16_f32 v25, v114, v115
    v_cvt_pk_bf16_f32 v37, v134, v135
    v_cvt_pk_bf16_f32 v14, v58, v60
    v_cvt_pk_bf16_f32 v26, v120, v122
    v_cvt_pk_bf16_f32 v38, v140, v142
    v_cvt_pk_bf16_f32 v15, v61, v62
    v_cvt_pk_bf16_f32 v27, v123, v124
    v_cvt_pk_bf16_f32 v39, v143, v144
    v_cvt_pk_bf16_f32 v16, v63, v68
    v_cvt_pk_bf16_f32 v28, v125, v130
    v_cvt_pk_bf16_f32 v40, v145, v150
    v_cvt_pk_bf16_f32 v18, v54, v55
    v_cvt_pk_bf16_f32 v30, v116, v117
    v_cvt_pk_bf16_f32 v42, v136, v137
    v_cvt_pk_bf16_f32 v19, v56, v57
    v_cvt_pk_bf16_f32 v31, v118, v119
    v_cvt_pk_bf16_f32 v43, v138, v139
    v_cvt_pk_bf16_f32 v20, v59, v64
    v_cvt_pk_bf16_f32 v32, v121, v126
    v_cvt_pk_bf16_f32 v44, v141, v146
    v_cvt_pk_bf16_f32 v21, v65, v66
    v_cvt_pk_bf16_f32 v33, v127, v128
    v_cvt_pk_bf16_f32 v45, v147, v148
    v_cvt_pk_bf16_f32 v22, v67, v69
    v_cvt_pk_bf16_f32 v34, v129, v131
    v_cvt_pk_bf16_f32 v46, v149, v151
    v_mov_b32 v17, 0
    v_mov_b32 v23, 0
    v_mov_b32 v29, 0
    v_mov_b32 v35, 0
    v_mov_b32 v41, 0
    v_mov_b32 v47, 0
    v_mov_b32 v48, 0
    v_mov_b32 v49, 0
    s_waitcnt vmcnt(0) lgkmcnt(0)
    s_barrier
    v_lshlrev_b32 v4, 4, v1
    v_add_u32 v4, 139264, v4
    v_lshlrev_b32 v5, 2, v1
    v_add_u32 v5, 143360, v5
    ds_read_b128 v[52:55], v4 offset:0
    ds_read_b32 v56, v5 offset:0
    ds_read_b128 v[60:63], v4 offset:1024
    ds_read_b32 v64, v5 offset:256
    ds_read_b128 v[68:71], v4 offset:2048
    ds_read_b32 v72, v5 offset:512
    ds_read_b128 v[76:79], v4 offset:3072
    ds_read_b32 v80, v5 offset:768
    v_mov_b32 v57, 0
    v_mov_b32 v58, 0
    v_mov_b32 v59, 0
    v_mov_b32 v65, 0
    v_mov_b32 v66, 0
    v_mov_b32 v67, 0
    v_mov_b32 v73, 0
    v_mov_b32 v74, 0
    v_mov_b32 v75, 0
    v_mov_b32 v81, 0
    v_mov_b32 v82, 0
    v_mov_b32 v83, 0
    s_mov_b32 s97, 0x358637bd
    s_mul_i32 s60, s35, 12
    s_mul_i32 s61, s38, 3
    s_add_u32 s60, s60, s61
    s_mul_i32 s60, s60, 20480
    s_mul_i32 s61, s80, 1280
    s_add_u32 s60, s60, s61
    s_add_u32 s60, s60, 1048576
    v_lshl_add_u32 v8, v1, 4, s60
    v_lshlrev_b32 v4, 4, v2
    v_lshl_add_u32 v4, v3, 3, v4
    s_add_u32 s60, s60, 1024
    v_add_u32 v9, s60, v4
    v_cmp_gt_u32 vcc, 16, v1
    s_mov_b32 s62, 20480
    s_mov_b32 s63, 40960
    s_waitcnt lgkmcnt(0)
    v_mfma_f32_16x16x32_bf16 v[84:87], v[52:55], v[12:15], 0
    v_mfma_f32_16x16x32_bf16 v[100:103], v[52:55], v[24:27], 0
    v_mfma_f32_16x16x32_bf16 v[116:119], v[52:55], v[36:39], 0
    v_mfma_f32_16x16x32_bf16 v[88:91], v[68:71], v[12:15], 0
    v_mfma_f32_16x16x32_bf16 v[104:107], v[68:71], v[24:27], 0
    v_mfma_f32_16x16x32_bf16 v[120:123], v[68:71], v[36:39], 0
    v_mfma_f32_16x16x32_bf16 v[84:87], v[56:59], v[16:19], v[84:87]
    v_mfma_f32_16x16x32_bf16 v[100:103], v[56:59], v[28:31], v[100:103]
    v_mfma_f32_16x16x32_bf16 v[116:119], v[56:59], v[40:43], v[116:119]
    v_mfma_f32_16x16x32_bf16 v[88:91], v[72:75], v[16:19], v[88:91]
    v_mfma_f32_16x16x32_bf16 v[104:107], v[72:75], v[28:31], v[104:107]
    v_mfma_f32_16x16x32_bf16 v[120:123], v[72:75], v[40:43], v[120:123]
    v_mfma_f32_16x16x32_bf16 v[92:95], v[60:63], v[18:21], 0
    v_mfma_f32_16x16x32_bf16 v[108:111], v[60:63], v[30:33], 0
    v_mfma_f32_16x16x32_bf16 v[124:127], v[60:63], v[42:45], 0
    v_mfma_f32_16x16x32_bf16 v[96:99], v[76:79], v[18:21], 0
    v_mfma_f32_16x16x32_bf16 v[112:115], v[76:79], v[30:33], 0
    v_mfma_f32_16x16x32_bf16 v[128:131], v[76:79], v[42:45], 0
    v_mfma_f32_16x16x32_bf16 v[92:95], v[64:67], v[22:25], v[92:95]
    v_mfma_f32_16x16x32_bf16 v[108:111], v[64:67], v[34:37], v[108:111]
    v_mfma_f32_16x16x32_bf16 v[124:127], v[64:67], v[46:49], v[124:127]
    v_mfma_f32_16x16x32_bf16 v[96:99], v[80:83], v[22:25], v[96:99]
    v_mfma_f32_16x16x32_bf16 v[112:115], v[80:83], v[34:37], v[112:115]
    v_mfma_f32_16x16x32_bf16 v[128:131], v[80:83], v[46:49], v[128:131]
    v_mov_b32 v138, v88
    v_mov_b32 v146, v104
    v_mov_b32 v154, v120
    s_nop 2
    v_mov_b32 v136, v96
    v_mov_b32 v144, v112
    v_mov_b32 v152, v128
    v_permlane16_swap_b32 v88, v138
    v_permlane16_swap_b32 v104, v146
    v_permlane16_swap_b32 v120, v154
    v_permlane16_swap_b32 v136, v96
    v_permlane16_swap_b32 v144, v112
    v_permlane16_swap_b32 v152, v128
    v_add_f32 v138, s97, v138
    v_add_f32 v146, s97, v146
    v_add_f32 v154, s97, v154
    v_add_f32 v136, s97, v136
    v_add_f32 v144, s97, v144
    v_add_f32 v152, s97, v152
    v_rcp_f32 v138, v138
    v_rcp_f32 v146, v146
    v_rcp_f32 v154, v154
    v_rcp_f32 v136, v136
    v_rcp_f32 v144, v144
    v_rcp_f32 v152, v152
    v_pk_mul_f32 v[84:85], v[84:85], v[138:139] op_sel:[0,0] op_sel_hi:[1,0]
    v_pk_mul_f32 v[100:101], v[100:101], v[146:147] op_sel:[0,0] op_sel_hi:[1,0]
    v_pk_mul_f32 v[116:117], v[116:117], v[154:155] op_sel:[0,0] op_sel_hi:[1,0]
    v_pk_mul_f32 v[86:87], v[86:87], v[138:139] op_sel:[0,0] op_sel_hi:[1,0]
    v_pk_mul_f32 v[102:103], v[102:103], v[146:147] op_sel:[0,0] op_sel_hi:[1,0]
    v_pk_mul_f32 v[118:119], v[118:119], v[154:155] op_sel:[0,0] op_sel_hi:[1,0]
    v_pk_mul_f32 v[88:89], v[88:89], v[138:139] op_sel:[0,0] op_sel_hi:[1,0]
    v_pk_mul_f32 v[104:105], v[104:105], v[146:147] op_sel:[0,0] op_sel_hi:[1,0]
    v_pk_mul_f32 v[120:121], v[120:121], v[154:155] op_sel:[0,0] op_sel_hi:[1,0]
    v_pk_mul_f32 v[90:91], v[90:91], v[138:139] op_sel:[0,0] op_sel_hi:[1,0]
    v_pk_mul_f32 v[106:107], v[106:107], v[146:147] op_sel:[0,0] op_sel_hi:[1,0]
    v_pk_mul_f32 v[122:123], v[122:123], v[154:155] op_sel:[0,0] op_sel_hi:[1,0]
    v_pk_mul_f32 v[92:93], v[92:93], v[136:137] op_sel:[0,0] op_sel_hi:[1,0]
    v_pk_mul_f32 v[108:109], v[108:109], v[144:145] op_sel:[0,0] op_sel_hi:[1,0]
    v_pk_mul_f32 v[124:125], v[124:125], v[152:153] op_sel:[0,0] op_sel_hi:[1,0]
    v_pk_mul_f32 v[94:95], v[94:95], v[136:137] op_sel:[0,0] op_sel_hi:[1,0]
    v_pk_mul_f32 v[110:111], v[110:111], v[144:145] op_sel:[0,0] op_sel_hi:[1,0]
    v_pk_mul_f32 v[126:127], v[126:127], v[152:153] op_sel:[0,0] op_sel_hi:[1,0]
    v_pk_mul_f32 v[96:97], v[96:97], v[136:137] op_sel:[0,0] op_sel_hi:[1,0]
    v_pk_mul_f32 v[112:113], v[112:113], v[144:145] op_sel:[0,0] op_sel_hi:[1,0]
    v_pk_mul_f32 v[128:129], v[128:129], v[152:153] op_sel:[0,0] op_sel_hi:[1,0]
    v_pk_mul_f32 v[98:99], v[98:99], v[136:137] op_sel:[0,0] op_sel_hi:[1,0]
    v_pk_mul_f32 v[114:115], v[114:115], v[144:145] op_sel:[0,0] op_sel_hi:[1,0]
    v_pk_mul_f32 v[130:131], v[130:131], v[152:153] op_sel:[0,0] op_sel_hi:[1,0]
    v_cvt_pk_bf16_f32 v132, v84, v85
    v_cvt_pk_bf16_f32 v140, v100, v101
    v_cvt_pk_bf16_f32 v148, v116, v117
    v_cvt_pk_bf16_f32 v133, v86, v87
    v_cvt_pk_bf16_f32 v141, v102, v103
    v_cvt_pk_bf16_f32 v149, v118, v119
    v_cvt_pk_bf16_f32 v134, v92, v93
    v_cvt_pk_bf16_f32 v142, v108, v109
    v_cvt_pk_bf16_f32 v150, v124, v125
    v_cvt_pk_bf16_f32 v135, v94, v95
    v_cvt_pk_bf16_f32 v143, v110, v111
    v_cvt_pk_bf16_f32 v151, v126, v127
    v_cvt_pk_bf16_f32 v88, v88, v89
    v_cvt_pk_bf16_f32 v104, v104, v105
    v_cvt_pk_bf16_f32 v120, v120, v121
    v_cvt_pk_bf16_f32 v89, v90, v91
    v_cvt_pk_bf16_f32 v105, v106, v107
    v_cvt_pk_bf16_f32 v121, v122, v123
    v_cvt_pk_bf16_f32 v96, v96, v97
    v_cvt_pk_bf16_f32 v112, v112, v113
    v_cvt_pk_bf16_f32 v128, v128, v129
    v_cvt_pk_bf16_f32 v97, v98, v99
    v_cvt_pk_bf16_f32 v113, v114, v115
    v_cvt_pk_bf16_f32 v129, v130, v131
    v_cndmask_b32 v136, v96, v88, vcc
    v_cndmask_b32 v144, v112, v104, vcc
    v_cndmask_b32 v152, v128, v120, vcc
    v_cndmask_b32 v137, v97, v89, vcc
    v_cndmask_b32 v145, v113, v105, vcc
    v_cndmask_b32 v153, v129, v121, vcc
    buffer_store_dwordx4 v[132:135], v8, s[48:51], 0 offen sc1
    buffer_store_dwordx4 v[140:143], v8, s[48:51], s62 offen sc1
    buffer_store_dwordx4 v[148:151], v8, s[48:51], s63 offen sc1
    s_mov_b32 exec_hi, 0
    buffer_store_dwordx2 v[136:137], v9, s[48:51], 0 offen sc1
    buffer_store_dwordx2 v[144:145], v9, s[48:51], s62 offen sc1
    buffer_store_dwordx2 v[152:153], v9, s[48:51], s63 offen sc1
    s_mov_b32 exec_hi, -1
    s_cmp_lg_u32 s38, 0
    s_cbranch_scc1 L_b_oclr_ok
    s_mov_b32 s101, 0
L_b_oclr:
    v_mov_b32 v10, 128
    global_load_dword v10, v10, s[28:29] sc1
    s_waitcnt vmcnt(0)
    v_readfirstlane_b32 s60, v10
    s_nop 3
    s_cmp_ge_u32 s60, 176
    s_cbranch_scc1 L_b_oclr_ok
    s_add_u32 s101, s101, 1
    s_cmp_gt_u32 s101, 4096
    s_cbranch_scc1 L_b_oclr_ok
    s_sleep 16
    s_branch L_b_oclr
L_b_oclr_ok:
    s_waitcnt vmcnt(0)
    s_barrier
L_b_final:
    s_cmp_ge_u32 s2, 160
    s_cbranch_scc1 L_b_done
    s_lshr_b32 s60, s2, 3
    s_cmp_ge_u32 s60, 10
    s_cselect_b32 s61, 1, 0
    s_and_b32 s62, s2, 7
    s_lshl_b32 s62, s62, 1
    s_add_u32 s92, s62, s61
    s_mul_i32 s61, s61, 10
    s_sub_u32 s93, s60, s61
    s_and_b32 s95, s37, 3
    s_lshr_b32 s96, s37, 2
    s_lshl_b32 s60, s92, 3
    s_lshl_b32 s61, s95, 1
    s_add_u32 s60, s60, s61
    s_mul_i32 s60, s60, 20480
    s_mul_i32 s61, s96, 10240
    s_add_u32 s60, s60, s61
    s_add_u32 s60, s60, 1048576
    v_lshl_add_u32 v88, v1, 4, s60
    s_mov_b32 s101, 0
    v_lshrrev_b32 v6, 2, v2
    v_bfe_u32 v7, v6, 1, 1
    v_and_b32 v4, 1, v3
    v_lshl_add_u32 v7, v4, 1, v7
    v_bfe_u32 v4, v2, 1, 1
    v_lshlrev_b32 v4, 4, v4
    v_and_b32 v5, 1, v2
    v_lshl_add_u32 v4, v5, 3, v4
    v_lshl_add_u32 v6, v3, 3, v6
    v_lshl_add_u32 v4, v6, 7, v4
    s_mul_i32 s61, s96, 40960
    v_add_u32 v4, s61, v4
    v_xor_b32 v5, 0, v7
    v_lshl_add_u32 v92, v5, 5, v4
    v_xor_b32 v5, 1, v7
    v_lshl_add_u32 v93, v5, 5, v4
    v_xor_b32 v5, 2, v7
    v_lshl_add_u32 v94, v5, 5, v4
    v_xor_b32 v5, 3, v7
    v_lshl_add_u32 v95, v5, 5, v4
    s_mov_b32 s61, 0
    buffer_load_dwordx4 v[8:11], v88, s[48:51], s61 offen offset:0 sc1
    s_mov_b32 s61, 20480
    buffer_load_dwordx4 v[12:15], v88, s[48:51], s61 offen offset:0 sc1
    s_mov_b32 s61, 0
    buffer_load_dwordx4 v[16:19], v88, s[48:51], s61 offen offset:1024 sc1
    s_mov_b32 s61, 20480
    buffer_load_dwordx4 v[20:23], v88, s[48:51], s61 offen offset:1024 sc1
    s_mov_b32 s61, 0
    buffer_load_dwordx4 v[24:27], v88, s[48:51], s61 offen offset:2048 sc1
    s_mov_b32 s61, 20480
    buffer_load_dwordx4 v[28:31], v88, s[48:51], s61 offen offset:2048 sc1
    s_mov_b32 s61, 0
    buffer_load_dwordx4 v[32:35], v88, s[48:51], s61 offen offset:3072 sc1
    s_mov_b32 s61, 20480
    buffer_load_dwordx4 v[36:39], v88, s[48:51], s61 offen offset:3072 sc1
    ds_read_b64_tr_b16 v[128:129], v92 offset:0
    ds_read_b64_tr_b16 v[130:131], v92 offset:512
    ds_read_b64_tr_b16 v[132:133], v93 offset:0
    ds_read_b64_tr_b16 v[134:135], v93 offset:512
    ds_read_b64_tr_b16 v[136:137], v94 offset:0
    ds_read_b64_tr_b16 v[138:139], v94 offset:512
    ds_read_b64_tr_b16 v[140:141], v95 offset:0
    ds_read_b64_tr_b16 v[142:143], v95 offset:512
    v_mov_b32 v96, 0
    v_mov_b32 v97, 0
    v_mov_b32 v98, 0
    v_mov_b32 v99, 0
    v_mov_b32 v100, 0
    v_mov_b32 v101, 0
    v_mov_b32 v102, 0
    v_mov_b32 v103, 0
    v_mov_b32 v104, 0
    v_mov_b32 v105, 0
    v_mov_b32 v106, 0
    v_mov_b32 v107, 0
    v_mov_b32 v108, 0
    v_mov_b32 v109, 0
    v_mov_b32 v110, 0
    v_mov_b32 v111, 0
    v_mov_b32 v112, 0
    v_mov_b32 v113, 0
    v_mov_b32 v114, 0
    v_mov_b32 v115, 0
    v_mov_b32 v116, 0
    v_mov_b32 v117, 0
    v_mov_b32 v118, 0
    v_mov_b32 v119, 0
    v_mov_b32 v120, 0
    v_mov_b32 v121, 0
    v_mov_b32 v122, 0
    v_mov_b32 v123, 0
    v_mov_b32 v124, 0
    v_mov_b32 v125, 0
    v_mov_b32 v126, 0
    v_mov_b32 v127, 0
    s_mov_b32 s90, 0
    s_waitcnt vmcnt(6)
    s_mov_b32 s61, 4096
    buffer_load_dwordx4 v[40:43], v88, s[48:51], s61 offen offset:0 sc1
    s_mov_b32 s61, 24576
    buffer_load_dwordx4 v[44:47], v88, s[48:51], s61 offen offset:0 sc1
    v_max3_u32 v90, v8, v9, v10
    v_max3_u32 v91, v11, v12, v13
    v_max3_u32 v90, v90, v14, v15
    v_max_u32 v90, v90, v91
    v_cmp_eq_u32 vcc, -1, v90
    s_cbranch_vccz L_b_ok2_0
    s_bitset1_b32 s90, 0
    s_mov_b32 s61, 0
    buffer_load_dwordx4 v[8:11], v88, s[48:51], s61 offen offset:0 sc1
    s_mov_b32 s61, 20480
    buffer_load_dwordx4 v[12:15], v88, s[48:51], s61 offen offset:0 sc1
    s_waitcnt lgkmcnt(0)
    ds_read_b64_tr_b16 v[144:145], v92 offset:4096
    ds_read_b64_tr_b16 v[146:147], v92 offset:4608
    ds_read_b64_tr_b16 v[148:149], v93 offset:4096
    ds_read_b64_tr_b16 v[150:151], v93 offset:4608
    ds_read_b64_tr_b16 v[152:153], v94 offset:4096
    ds_read_b64_tr_b16 v[154:155], v94 offset:4608
    ds_read_b64_tr_b16 v[156:157], v95 offset:4096
    ds_read_b64_tr_b16 v[158:159], v95 offset:4608
    s_branch L_b_nx2_0
L_b_ok2_0:
    s_waitcnt lgkmcnt(0)
    v_mfma_f32_16x16x32_bf16 v[96:99], v[128:131], v[8:11], v[96:99]
    ds_read_b64_tr_b16 v[144:145], v92 offset:4096
    ds_read_b64_tr_b16 v[146:147], v92 offset:4608
    v_mfma_f32_16x16x32_bf16 v[112:115], v[128:131], v[12:15], v[112:115]
    ds_read_b64_tr_b16 v[148:149], v93 offset:4096
    ds_read_b64_tr_b16 v[150:151], v93 offset:4608
    v_mfma_f32_16x16x32_bf16 v[100:103], v[132:135], v[8:11], v[100:103]
    ds_read_b64_tr_b16 v[152:153], v94 offset:4096
    ds_read_b64_tr_b16 v[154:155], v94 offset:4608
    v_mfma_f32_16x16x32_bf16 v[116:119], v[132:135], v[12:15], v[116:119]
    ds_read_b64_tr_b16 v[156:157], v95 offset:4096
    ds_read_b64_tr_b16 v[158:159], v95 offset:4608
    v_mfma_f32_16x16x32_bf16 v[104:107], v[136:139], v[8:11], v[104:107]
    v_mfma_f32_16x16x32_bf16 v[120:123], v[136:139], v[12:15], v[120:123]
    v_mfma_f32_16x16x32_bf16 v[108:111], v[140:143], v[8:11], v[108:111]
    v_mfma_f32_16x16x32_bf16 v[124:127], v[140:143], v[12:15], v[124:127]
L_b_nx2_0:
    s_waitcnt vmcnt(6)
    s_mov_b32 s61, 4096
    buffer_load_dwordx4 v[48:51], v88, s[48:51], s61 offen offset:1024 sc1
    s_mov_b32 s61, 24576
    buffer_load_dwordx4 v[52:55], v88, s[48:51], s61 offen offset:1024 sc1
    v_max3_u32 v90, v16, v17, v18
    v_max3_u32 v91, v19, v20, v21
    v_max3_u32 v90, v90, v22, v23
    v_max_u32 v90, v90, v91
    v_cmp_eq_u32 vcc, -1, v90
    s_cbranch_vccz L_b_ok2_1
    s_bitset1_b32 s90, 1
    s_mov_b32 s61, 0
    buffer_load_dwordx4 v[16:19], v88, s[48:51], s61 offen offset:1024 sc1
    s_mov_b32 s61, 20480
    buffer_load_dwordx4 v[20:23], v88, s[48:51], s61 offen offset:1024 sc1
    s_waitcnt lgkmcnt(0)
    ds_read_b64_tr_b16 v[128:129], v92 offset:8192
    ds_read_b64_tr_b16 v[130:131], v92 offset:8704
    ds_read_b64_tr_b16 v[132:133], v93 offset:8192
    ds_read_b64_tr_b16 v[134:135], v93 offset:8704
    ds_read_b64_tr_b16 v[136:137], v94 offset:8192
    ds_read_b64_tr_b16 v[138:139], v94 offset:8704
    ds_read_b64_tr_b16 v[140:141], v95 offset:8192
    ds_read_b64_tr_b16 v[142:143], v95 offset:8704
    s_branch L_b_nx2_1
L_b_ok2_1:
    s_waitcnt lgkmcnt(0)
    v_mfma_f32_16x16x32_bf16 v[96:99], v[144:147], v[16:19], v[96:99]
    ds_read_b64_tr_b16 v[128:129], v92 offset:8192
    ds_read_b64_tr_b16 v[130:131], v92 offset:8704
    v_mfma_f32_16x16x32_bf16 v[112:115], v[144:147], v[20:23], v[112:115]
    ds_read_b64_tr_b16 v[132:133], v93 offset:8192
    ds_read_b64_tr_b16 v[134:135], v93 offset:8704
    v_mfma_f32_16x16x32_bf16 v[100:103], v[148:151], v[16:19], v[100:103]
    ds_read_b64_tr_b16 v[136:137], v94 offset:8192
    ds_read_b64_tr_b16 v[138:139], v94 offset:8704
    v_mfma_f32_16x16x32_bf16 v[116:119], v[148:151], v[20:23], v[116:119]
    ds_read_b64_tr_b16 v[140:141], v95 offset:8192
    ds_read_b64_tr_b16 v[142:143], v95 offset:8704
    v_mfma_f32_16x16x32_bf16 v[104:107], v[152:155], v[16:19], v[104:107]
    v_mfma_f32_16x16x32_bf16 v[120:123], v[152:155], v[20:23], v[120:123]
    v_mfma_f32_16x16x32_bf16 v[108:111], v[156:159], v[16:19], v[108:111]
    v_mfma_f32_16x16x32_bf16 v[124:127], v[156:159], v[20:23], v[124:127]
L_b_nx2_1:
    s_waitcnt vmcnt(6)
    s_mov_b32 s61, 4096
    buffer_load_dwordx4 v[56:59], v88, s[48:51], s61 offen offset:2048 sc1
    s_mov_b32 s61, 24576
    buffer_load_dwordx4 v[60:63], v88, s[48:51], s61 offen offset:2048 sc1
    v_max3_u32 v90, v24, v25, v26
    v_max3_u32 v91, v27, v28, v29
    v_max3_u32 v90, v90, v30, v31
    v_max_u32 v90, v90, v91
    v_cmp_eq_u32 vcc, -1, v90
    s_cbranch_vccz L_b_ok2_2
    s_bitset1_b32 s90, 2
    s_mov_b32 s61, 0
    buffer_load_dwordx4 v[24:27], v88, s[48:51], s61 offen offset:2048 sc1
    s_mov_b32 s61, 20480
    buffer_load_dwordx4 v[28:31], v88, s[48:51], s61 offen offset:2048 sc1
    s_waitcnt lgkmcnt(0)
    ds_read_b64_tr_b16 v[144:145], v92 offset:12288
    ds_read_b64_tr_b16 v[146:147], v92 offset:12800
    ds_read_b64_tr_b16 v[148:149], v93 offset:12288
    ds_read_b64_tr_b16 v[150:151], v93 offset:12800
    ds_read_b64_tr_b16 v[152:153], v94 offset:12288
    ds_read_b64_tr_b16 v[154:155], v94 offset:12800
    ds_read_b64_tr_b16 v[156:157], v95 offset:12288
    ds_read_b64_tr_b16 v[158:159], v95 offset:12800
    s_branch L_b_nx2_2
L_b_ok2_2:
    s_waitcnt lgkmcnt(0)
    v_mfma_f32_16x16x32_bf16 v[96:99], v[128:131], v[24:27], v[96:99]
    ds_read_b64_tr_b16 v[144:145], v92 offset:12288
    ds_read_b64_tr_b16 v[146:147], v92 offset:12800
    v_mfma_f32_16x16x32_bf16 v[112:115], v[128:131], v[28:31], v[112:115]
    ds_read_b64_tr_b16 v[148:149], v93 offset:12288
    ds_read_b64_tr_b16 v[150:151], v93 offset:12800
    v_mfma_f32_16x16x32_bf16 v[100:103], v[132:135], v[24:27], v[100:103]
    ds_read_b64_tr_b16 v[152:153], v94 offset:12288
    ds_read_b64_tr_b16 v[154:155], v94 offset:12800
    v_mfma_f32_16x16x32_bf16 v[116:119], v[132:135], v[28:31], v[116:119]
    ds_read_b64_tr_b16 v[156:157], v95 offset:12288
    ds_read_b64_tr_b16 v[158:159], v95 offset:12800
    v_mfma_f32_16x16x32_bf16 v[104:107], v[136:139], v[24:27], v[104:107]
    v_mfma_f32_16x16x32_bf16 v[120:123], v[136:139], v[28:31], v[120:123]
    v_mfma_f32_16x16x32_bf16 v[108:111], v[140:143], v[24:27], v[108:111]
    v_mfma_f32_16x16x32_bf16 v[124:127], v[140:143], v[28:31], v[124:127]
L_b_nx2_2:
    s_waitcnt vmcnt(6)
    s_mov_b32 s61, 4096
    buffer_load_dwordx4 v[64:67], v88, s[48:51], s61 offen offset:3072 sc1
    s_mov_b32 s61, 24576
    buffer_load_dwordx4 v[68:71], v88, s[48:51], s61 offen offset:3072 sc1
    v_max3_u32 v90, v32, v33, v34
    v_max3_u32 v91, v35, v36, v37
    v_max3_u32 v90, v90, v38, v39
    v_max_u32 v90, v90, v91
    v_cmp_eq_u32 vcc, -1, v90
    s_cbranch_vccz L_b_ok2_3
    s_bitset1_b32 s90, 3
    s_mov_b32 s61, 0
    buffer_load_dwordx4 v[32:35], v88, s[48:51], s61 offen offset:3072 sc1
    s_mov_b32 s61, 20480
    buffer_load_dwordx4 v[36:39], v88, s[48:51], s61 offen offset:3072 sc1
    s_waitcnt lgkmcnt(0)
    ds_read_b64_tr_b16 v[128:129], v92 offset:16384
    ds_read_b64_tr_b16 v[130:131], v92 offset:16896
    ds_read_b64_tr_b16 v[132:133], v93 offset:16384
    ds_read_b64_tr_b16 v[134:135], v93 offset:16896
    ds_read_b64_tr_b16 v[136:137], v94 offset:16384
    ds_read_b64_tr_b16 v[138:139], v94 offset:16896
    ds_read_b64_tr_b16 v[140:141], v95 offset:16384
    ds_read_b64_tr_b16 v[142:143], v95 offset:16896
    s_branch L_b_nx2_3
L_b_ok2_3:
    s_waitcnt lgkmcnt(0)
    v_mfma_f32_16x16x32_bf16 v[96:99], v[144:147], v[32:35], v[96:99]
    ds_read_b64_tr_b16 v[128:129], v92 offset:16384
    ds_read_b64_tr_b16 v[130:131], v92 offset:16896
    v_mfma_f32_16x16x32_bf16 v[112:115], v[144:147], v[36:39], v[112:115]
    ds_read_b64_tr_b16 v[132:133], v93 offset:16384
    ds_read_b64_tr_b16 v[134:135], v93 offset:16896
    v_mfma_f32_16x16x32_bf16 v[100:103], v[148:151], v[32:35], v[100:103]
    ds_read_b64_tr_b16 v[136:137], v94 offset:16384
    ds_read_b64_tr_b16 v[138:139], v94 offset:16896
    v_mfma_f32_16x16x32_bf16 v[116:119], v[148:151], v[36:39], v[116:119]
    ds_read_b64_tr_b16 v[140:141], v95 offset:16384
    ds_read_b64_tr_b16 v[142:143], v95 offset:16896
    v_mfma_f32_16x16x32_bf16 v[104:107], v[152:155], v[32:35], v[104:107]
    v_mfma_f32_16x16x32_bf16 v[120:123], v[152:155], v[36:39], v[120:123]
    v_mfma_f32_16x16x32_bf16 v[108:111], v[156:159], v[32:35], v[108:111]
    v_mfma_f32_16x16x32_bf16 v[124:127], v[156:159], v[36:39], v[124:127]
L_b_nx2_3:
    s_waitcnt vmcnt(6)
    s_mov_b32 s61, 8192
    buffer_load_dwordx4 v[72:75], v88, s[48:51], s61 offen offset:0 sc1
    s_mov_b32 s61, 28672
    buffer_load_dwordx4 v[76:79], v88, s[48:51], s61 offen offset:0 sc1
    v_max3_u32 v90, v40, v41, v42
    v_max3_u32 v91, v43, v44, v45
    v_max3_u32 v90, v90, v46, v47
    v_max_u32 v90, v90, v91
    v_cmp_eq_u32 vcc, -1, v90
    s_cbranch_vccz L_b_ok2_4
    s_bitset1_b32 s90, 4
    s_mov_b32 s61, 4096
    buffer_load_dwordx4 v[40:43], v88, s[48:51], s61 offen offset:0 sc1
    s_mov_b32 s61, 24576
    buffer_load_dwordx4 v[44:47], v88, s[48:51], s61 offen offset:0 sc1
    s_waitcnt lgkmcnt(0)
    ds_read_b64_tr_b16 v[144:145], v92 offset:20480
    ds_read_b64_tr_b16 v[146:147], v92 offset:20992
    ds_read_b64_tr_b16 v[148:149], v93 offset:20480
    ds_read_b64_tr_b16 v[150:151], v93 offset:20992
    ds_read_b64_tr_b16 v[152:153], v94 offset:20480
    ds_read_b64_tr_b16 v[154:155], v94 offset:20992
    ds_read_b64_tr_b16 v[156:157], v95 offset:20480
    ds_read_b64_tr_b16 v[158:159], v95 offset:20992
    s_branch L_b_nx2_4
L_b_ok2_4:
    s_waitcnt lgkmcnt(0)
    v_mfma_f32_16x16x32_bf16 v[96:99], v[128:131], v[40:43], v[96:99]
    ds_read_b64_tr_b16 v[144:145], v92 offset:20480
    ds_read_b64_tr_b16 v[146:147], v92 offset:20992
    v_mfma_f32_16x16x32_bf16 v[112:115], v[128:131], v[44:47], v[112:115]
    ds_read_b64_tr_b16 v[148:149], v93 offset:20480
    ds_read_b64_tr_b16 v[150:151], v93 offset:20992
    v_mfma_f32_16x16x32_bf16 v[100:103], v[132:135], v[40:43], v[100:103]
    ds_read_b64_tr_b16 v[152:153], v94 offset:20480
    ds_read_b64_tr_b16 v[154:155], v94 offset:20992
    v_mfma_f32_16x16x32_bf16 v[116:119], v[132:135], v[44:47], v[116:119]
    ds_read_b64_tr_b16 v[156:157], v95 offset:20480
    ds_read_b64_tr_b16 v[158:159], v95 offset:20992
    v_mfma_f32_16x16x32_bf16 v[104:107], v[136:139], v[40:43], v[104:107]
    v_mfma_f32_16x16x32_bf16 v[120:123], v[136:139], v[44:47], v[120:123]
    v_mfma_f32_16x16x32_bf16 v[108:111], v[140:143], v[40:43], v[108:111]
    v_mfma_f32_16x16x32_bf16 v[124:127], v[140:143], v[44:47], v[124:127]
L_b_nx2_4:
    s_waitcnt vmcnt(6)
    s_mov_b32 s61, 8192
    buffer_load_dwordx4 v[80:83], v88, s[48:51], s61 offen offset:1024 sc1
    s_mov_b32 s61, 28672
    buffer_load_dwordx4 v[84:87], v88, s[48:51], s61 offen offset:1024 sc1
    v_max3_u32 v90, v48, v49, v50
    v_max3_u32 v91, v51, v52, v53
    v_max3_u32 v90, v90, v54, v55
    v_max_u32 v90, v90, v91
    v_cmp_eq_u32 vcc, -1, v90
    s_cbranch_vccz L_b_ok2_5
    s_bitset1_b32 s90, 5
    s_mov_b32 s61, 4096
    buffer_load_dwordx4 v[48:51], v88, s[48:51], s61 offen offset:1024 sc1
    s_mov_b32 s61, 24576
    buffer_load_dwordx4 v[52:55], v88, s[48:51], s61 offen offset:1024 sc1
    s_waitcnt lgkmcnt(0)
    ds_read_b64_tr_b16 v[128:129], v92 offset:24576
    ds_read_b64_tr_b16 v[130:131], v92 offset:25088
    ds_read_b64_tr_b16 v[132:133], v93 offset:24576
    ds_read_b64_tr_b16 v[134:135], v93 offset:25088
    ds_read_b64_tr_b16 v[136:137], v94 offset:24576
    ds_read_b64_tr_b16 v[138:139], v94 offset:25088
    ds_read_b64_tr_b16 v[140:141], v95 offset:24576
    ds_read_b64_tr_b16 v[142:143], v95 offset:25088
    s_branch L_b_nx2_5
L_b_ok2_5:
    s_waitcnt lgkmcnt(0)
    v_mfma_f32_16x16x32_bf16 v[96:99], v[144:147], v[48:51], v[96:99]
    ds_read_b64_tr_b16 v[128:129], v92 offset:24576
    ds_read_b64_tr_b16 v[130:131], v92 offset:25088
    v_mfma_f32_16x16x32_bf16 v[112:115], v[144:147], v[52:55], v[112:115]
    ds_read_b64_tr_b16 v[132:133], v93 offset:24576
    ds_read_b64_tr_b16 v[134:135], v93 offset:25088
    v_mfma_f32_16x16x32_bf16 v[100:103], v[148:151], v[48:51], v[100:103]
    ds_read_b64_tr_b16 v[136:137], v94 offset:24576
    ds_read_b64_tr_b16 v[138:139], v94 offset:25088
    v_mfma_f32_16x16x32_bf16 v[116:119], v[148:151], v[52:55], v[116:119]
    ds_read_b64_tr_b16 v[140:141], v95 offset:24576
    ds_read_b64_tr_b16 v[142:143], v95 offset:25088
    v_mfma_f32_16x16x32_bf16 v[104:107], v[152:155], v[48:51], v[104:107]
    v_mfma_f32_16x16x32_bf16 v[120:123], v[152:155], v[52:55], v[120:123]
    v_mfma_f32_16x16x32_bf16 v[108:111], v[156:159], v[48:51], v[108:111]
    v_mfma_f32_16x16x32_bf16 v[124:127], v[156:159], v[52:55], v[124:127]
L_b_nx2_5:
    s_waitcnt vmcnt(6)
    v_max3_u32 v90, v56, v57, v58
    v_max3_u32 v91, v59, v60, v61
    v_max3_u32 v90, v90, v62, v63
    v_max_u32 v90, v90, v91
    v_cmp_eq_u32 vcc, -1, v90
    s_cbranch_vccz L_b_ok2_6
    s_bitset1_b32 s90, 6
    s_mov_b32 s61, 4096
    buffer_load_dwordx4 v[56:59], v88, s[48:51], s61 offen offset:2048 sc1
    s_mov_b32 s61, 24576
    buffer_load_dwordx4 v[60:63], v88, s[48:51], s61 offen offset:2048 sc1
    s_waitcnt lgkmcnt(0)
    ds_read_b64_tr_b16 v[144:145], v92 offset:28672
    ds_read_b64_tr_b16 v[146:147], v92 offset:29184
    ds_read_b64_tr_b16 v[148:149], v93 offset:28672
    ds_read_b64_tr_b16 v[150:151], v93 offset:29184
    ds_read_b64_tr_b16 v[152:153], v94 offset:28672
    ds_read_b64_tr_b16 v[154:155], v94 offset:29184
    ds_read_b64_tr_b16 v[156:157], v95 offset:28672
    ds_read_b64_tr_b16 v[158:159], v95 offset:29184
    s_branch L_b_nx2_6
L_b_ok2_6:
    s_waitcnt lgkmcnt(0)
    v_mfma_f32_16x16x32_bf16 v[96:99], v[128:131], v[56:59], v[96:99]
    ds_read_b64_tr_b16 v[144:145], v92 offset:28672
    ds_read_b64_tr_b16 v[146:147], v92 offset:29184
    v_mfma_f32_16x16x32_bf16 v[112:115], v[128:131], v[60:63], v[112:115]
    ds_read_b64_tr_b16 v[148:149], v93 offset:28672
    ds_read_b64_tr_b16 v[150:151], v93 offset:29184
    v_mfma_f32_16x16x32_bf16 v[100:103], v[132:135], v[56:59], v[100:103]
    ds_read_b64_tr_b16 v[152:153], v94 offset:28672
    ds_read_b64_tr_b16 v[154:155], v94 offset:29184
    v_mfma_f32_16x16x32_bf16 v[116:119], v[132:135], v[60:63], v[116:119]
    ds_read_b64_tr_b16 v[156:157], v95 offset:28672
    ds_read_b64_tr_b16 v[158:159], v95 offset:29184
    v_mfma_f32_16x16x32_bf16 v[104:107], v[136:139], v[56:59], v[104:107]
    v_mfma_f32_16x16x32_bf16 v[120:123], v[136:139], v[60:63], v[120:123]
    v_mfma_f32_16x16x32_bf16 v[108:111], v[140:143], v[56:59], v[108:111]
    v_mfma_f32_16x16x32_bf16 v[124:127], v[140:143], v[60:63], v[124:127]
L_b_nx2_6:
    s_waitcnt vmcnt(4)
    v_max3_u32 v90, v64, v65, v66
    v_max3_u32 v91, v67, v68, v69
    v_max3_u32 v90, v90, v70, v71
    v_max_u32 v90, v90, v91
    v_cmp_eq_u32 vcc, -1, v90
    s_cbranch_vccz L_b_ok2_7
    s_bitset1_b32 s90, 7
    s_mov_b32 s61, 4096
    buffer_load_dwordx4 v[64:67], v88, s[48:51], s61 offen offset:3072 sc1
    s_mov_b32 s61, 24576
    buffer_load_dwordx4 v[68:71], v88, s[48:51], s61 offen offset:3072 sc1
    s_waitcnt lgkmcnt(0)
    ds_read_b64_tr_b16 v[128:129], v92 offset:32768
    ds_read_b64_tr_b16 v[130:131], v92 offset:33280
    ds_read_b64_tr_b16 v[132:133], v93 offset:32768
    ds_read_b64_tr_b16 v[134:135], v93 offset:33280
    ds_read_b64_tr_b16 v[136:137], v94 offset:32768
    ds_read_b64_tr_b16 v[138:139], v94 offset:33280
    ds_read_b64_tr_b16 v[140:141], v95 offset:32768
    ds_read_b64_tr_b16 v[142:143], v95 offset:33280
    s_branch L_b_nx2_7
L_b_ok2_7:
    s_waitcnt lgkmcnt(0)
    v_mfma_f32_16x16x32_bf16 v[96:99], v[144:147], v[64:67], v[96:99]
    ds_read_b64_tr_b16 v[128:129], v92 offset:32768
    ds_read_b64_tr_b16 v[130:131], v92 offset:33280
    v_mfma_f32_16x16x32_bf16 v[112:115], v[144:147], v[68:71], v[112:115]
    ds_read_b64_tr_b16 v[132:133], v93 offset:32768
    ds_read_b64_tr_b16 v[134:135], v93 offset:33280
    v_mfma_f32_16x16x32_bf16 v[100:103], v[148:151], v[64:67], v[100:103]
    ds_read_b64_tr_b16 v[136:137], v94 offset:32768
    ds_read_b64_tr_b16 v[138:139], v94 offset:33280
    v_mfma_f32_16x16x32_bf16 v[116:119], v[148:151], v[68:71], v[116:119]
    ds_read_b64_tr_b16 v[140:141], v95 offset:32768
    ds_read_b64_tr_b16 v[142:143], v95 offset:33280
    v_mfma_f32_16x16x32_bf16 v[104:107], v[152:155], v[64:67], v[104:107]
    v_mfma_f32_16x16x32_bf16 v[120:123], v[152:155], v[68:71], v[120:123]
    v_mfma_f32_16x16x32_bf16 v[108:111], v[156:159], v[64:67], v[108:111]
    v_mfma_f32_16x16x32_bf16 v[124:127], v[156:159], v[68:71], v[124:127]
L_b_nx2_7:
    s_waitcnt vmcnt(2)
    v_max3_u32 v90, v72, v73, v74
    v_max3_u32 v91, v75, v76, v77
    v_max3_u32 v90, v90, v78, v79
    v_max_u32 v90, v90, v91
    v_cmp_eq_u32 vcc, -1, v90
    s_cbranch_vccz L_b_ok2_8
    s_bitset1_b32 s90, 8
    s_mov_b32 s61, 8192
    buffer_load_dwordx4 v[72:75], v88, s[48:51], s61 offen offset:0 sc1
    s_mov_b32 s61, 28672
    buffer_load_dwordx4 v[76:79], v88, s[48:51], s61 offen offset:0 sc1
    s_waitcnt lgkmcnt(0)
    ds_read_b64_tr_b16 v[144:145], v92 offset:36864
    ds_read_b64_tr_b16 v[146:147], v92 offset:37376
    ds_read_b64_tr_b16 v[148:149], v93 offset:36864
    ds_read_b64_tr_b16 v[150:151], v93 offset:37376
    ds_read_b64_tr_b16 v[152:153], v94 offset:36864
    ds_read_b64_tr_b16 v[154:155], v94 offset:37376
    ds_read_b64_tr_b16 v[156:157], v95 offset:36864
    ds_read_b64_tr_b16 v[158:159], v95 offset:37376
    s_branch L_b_nx2_8
L_b_ok2_8:
    s_waitcnt lgkmcnt(0)
    v_mfma_f32_16x16x32_bf16 v[96:99], v[128:131], v[72:75], v[96:99]
    ds_read_b64_tr_b16 v[144:145], v92 offset:36864
    ds_read_b64_tr_b16 v[146:147], v92 offset:37376
    v_mfma_f32_16x16x32_bf16 v[112:115], v[128:131], v[76:79], v[112:115]
    ds_read_b64_tr_b16 v[148:149], v93 offset:36864
    ds_read_b64_tr_b16 v[150:151], v93 offset:37376
    v_mfma_f32_16x16x32_bf16 v[100:103], v[132:135], v[72:75], v[100:103]
    ds_read_b64_tr_b16 v[152:153], v94 offset:36864
    ds_read_b64_tr_b16 v[154:155], v94 offset:37376
    v_mfma_f32_16x16x32_bf16 v[116:119], v[132:135], v[76:79], v[116:119]
    ds_read_b64_tr_b16 v[156:157], v95 offset:36864
    ds_read_b64_tr_b16 v[158:159], v95 offset:37376
    v_mfma_f32_16x16x32_bf16 v[104:107], v[136:139], v[72:75], v[104:107]
    v_mfma_f32_16x16x32_bf16 v[120:123], v[136:139], v[76:79], v[120:123]
    v_mfma_f32_16x16x32_bf16 v[108:111], v[140:143], v[72:75], v[108:111]
    v_mfma_f32_16x16x32_bf16 v[124:127], v[140:143], v[76:79], v[124:127]
L_b_nx2_8:
    s_waitcnt vmcnt(0)
    v_max3_u32 v90, v80, v81, v82
    v_max3_u32 v91, v83, v84, v85
    v_max3_u32 v90, v90, v86, v87
    v_max_u32 v90, v90, v91
    v_cmp_eq_u32 vcc, -1, v90
    s_cbranch_vccz L_b_ok2_9
    s_bitset1_b32 s90, 9
    s_mov_b32 s61, 8192
    buffer_load_dwordx4 v[80:83], v88, s[48:51], s61 offen offset:1024 sc1
    s_mov_b32 s61, 28672
    buffer_load_dwordx4 v[84:87], v88, s[48:51], s61 offen offset:1024 sc1
    s_waitcnt lgkmcnt(0)
    s_branch L_b_nx2_9
L_b_ok2_9:
    s_waitcnt lgkmcnt(0)
    v_mfma_f32_16x16x32_bf16 v[96:99], v[144:147], v[80:83], v[96:99]
    v_mfma_f32_16x16x32_bf16 v[112:115], v[144:147], v[84:87], v[112:115]
    v_mfma_f32_16x16x32_bf16 v[100:103], v[148:151], v[80:83], v[100:103]
    v_mfma_f32_16x16x32_bf16 v[116:119], v[148:151], v[84:87], v[116:119]
    v_mfma_f32_16x16x32_bf16 v[104:107], v[152:155], v[80:83], v[104:107]
    v_mfma_f32_16x16x32_bf16 v[120:123], v[152:155], v[84:87], v[120:123]
    v_mfma_f32_16x16x32_bf16 v[108:111], v[156:159], v[80:83], v[108:111]
    v_mfma_f32_16x16x32_bf16 v[124:127], v[156:159], v[84:87], v[124:127]
L_b_nx2_9:
    s_cmp_eq_u32 s90, 0
    s_cbranch_scc1 L_b_ok2
L_b_p2:
    s_waitcnt vmcnt(0)
    s_bitcmp1_b32 s90, 0
    s_cbranch_scc0 L_b_p2n_0
    v_max3_u32 v90, v8, v9, v10
    v_max3_u32 v91, v11, v12, v13
    v_max3_u32 v90, v90, v14, v15
    v_max_u32 v90, v90, v91
    v_cmp_eq_u32 vcc, -1, v90
    s_cbranch_vccnz L_b_p2r_0
    ds_read_b64_tr_b16 v[128:129], v92 offset:0
    ds_read_b64_tr_b16 v[130:131], v92 offset:512
    ds_read_b64_tr_b16 v[132:133], v93 offset:0
    ds_read_b64_tr_b16 v[134:135], v93 offset:512
    ds_read_b64_tr_b16 v[136:137], v94 offset:0
    ds_read_b64_tr_b16 v[138:139], v94 offset:512
    ds_read_b64_tr_b16 v[140:141], v95 offset:0
    ds_read_b64_tr_b16 v[142:143], v95 offset:512
    s_waitcnt lgkmcnt(0)
    v_mfma_f32_16x16x32_bf16 v[96:99], v[128:131], v[8:11], v[96:99]
    v_mfma_f32_16x16x32_bf16 v[112:115], v[128:131], v[12:15], v[112:115]
    v_mfma_f32_16x16x32_bf16 v[100:103], v[132:135], v[8:11], v[100:103]
    v_mfma_f32_16x16x32_bf16 v[116:119], v[132:135], v[12:15], v[116:119]
    v_mfma_f32_16x16x32_bf16 v[104:107], v[136:139], v[8:11], v[104:107]
    v_mfma_f32_16x16x32_bf16 v[120:123], v[136:139], v[12:15], v[120:123]
    v_mfma_f32_16x16x32_bf16 v[108:111], v[140:143], v[8:11], v[108:111]
    v_mfma_f32_16x16x32_bf16 v[124:127], v[140:143], v[12:15], v[124:127]
    s_bitset0_b32 s90, 0
    s_branch L_b_p2n_0
L_b_p2r_0:
    s_mov_b32 s61, 0
    buffer_load_dwordx4 v[8:11], v88, s[48:51], s61 offen offset:0 sc1
    s_mov_b32 s61, 20480
    buffer_load_dwordx4 v[12:15], v88, s[48:51], s61 offen offset:0 sc1
L_b_p2n_0:
    s_bitcmp1_b32 s90, 1
    s_cbranch_scc0 L_b_p2n_1
    v_max3_u32 v90, v16, v17, v18
    v_max3_u32 v91, v19, v20, v21
    v_max3_u32 v90, v90, v22, v23
    v_max_u32 v90, v90, v91
    v_cmp_eq_u32 vcc, -1, v90
    s_cbranch_vccnz L_b_p2r_1
    ds_read_b64_tr_b16 v[128:129], v92 offset:4096
    ds_read_b64_tr_b16 v[130:131], v92 offset:4608
    ds_read_b64_tr_b16 v[132:133], v93 offset:4096
    ds_read_b64_tr_b16 v[134:135], v93 offset:4608
    ds_read_b64_tr_b16 v[136:137], v94 offset:4096
    ds_read_b64_tr_b16 v[138:139], v94 offset:4608
    ds_read_b64_tr_b16 v[140:141], v95 offset:4096
    ds_read_b64_tr_b16 v[142:143], v95 offset:4608
    s_waitcnt lgkmcnt(0)
    v_mfma_f32_16x16x32_bf16 v[96:99], v[128:131], v[16:19], v[96:99]
    v_mfma_f32_16x16x32_bf16 v[112:115], v[128:131], v[20:23], v[112:115]
    v_mfma_f32_16x16x32_bf16 v[100:103], v[132:135], v[16:19], v[100:103]
    v_mfma_f32_16x16x32_bf16 v[116:119], v[132:135], v[20:23], v[116:119]
    v_mfma_f32_16x16x32_bf16 v[104:107], v[136:139], v[16:19], v[104:107]
    v_mfma_f32_16x16x32_bf16 v[120:123], v[136:139], v[20:23], v[120:123]
    v_mfma_f32_16x16x32_bf16 v[108:111], v[140:143], v[16:19], v[108:111]
    v_mfma_f32_16x16x32_bf16 v[124:127], v[140:143], v[20:23], v[124:127]
    s_bitset0_b32 s90, 1
    s_branch L_b_p2n_1
L_b_p2r_1:
    s_mov_b32 s61, 0
    buffer_load_dwordx4 v[16:19], v88, s[48:51], s61 offen offset:1024 sc1
    s_mov_b32 s61, 20480
    buffer_load_dwordx4 v[20:23], v88, s[48:51], s61 offen offset:1024 sc1
L_b_p2n_1:
    s_bitcmp1_b32 s90, 2
    s_cbranch_scc0 L_b_p2n_2
    v_max3_u32 v90, v24, v25, v26
    v_max3_u32 v91, v27, v28, v29
    v_max3_u32 v90, v90, v30, v31
    v_max_u32 v90, v90, v91
    v_cmp_eq_u32 vcc, -1, v90
    s_cbranch_vccnz L_b_p2r_2
    ds_read_b64_tr_b16 v[128:129], v92 offset:8192
    ds_read_b64_tr_b16 v[130:131], v92 offset:8704
    ds_read_b64_tr_b16 v[132:133], v93 offset:8192
    ds_read_b64_tr_b16 v[134:135], v93 offset:8704
    ds_read_b64_tr_b16 v[136:137], v94 offset:8192
    ds_read_b64_tr_b16 v[138:139], v94 offset:8704
    ds_read_b64_tr_b16 v[140:141], v95 offset:8192
    ds_read_b64_tr_b16 v[142:143], v95 offset:8704
    s_waitcnt lgkmcnt(0)
    v_mfma_f32_16x16x32_bf16 v[96:99], v[128:131], v[24:27], v[96:99]
    v_mfma_f32_16x16x32_bf16 v[112:115], v[128:131], v[28:31], v[112:115]
    v_mfma_f32_16x16x32_bf16 v[100:103], v[132:135], v[24:27], v[100:103]
    v_mfma_f32_16x16x32_bf16 v[116:119], v[132:135], v[28:31], v[116:119]
    v_mfma_f32_16x16x32_bf16 v[104:107], v[136:139], v[24:27], v[104:107]
    v_mfma_f32_16x16x32_bf16 v[120:123], v[136:139], v[28:31], v[120:123]
    v_mfma_f32_16x16x32_bf16 v[108:111], v[140:143], v[24:27], v[108:111]
    v_mfma_f32_16x16x32_bf16 v[124:127], v[140:143], v[28:31], v[124:127]
    s_bitset0_b32 s90, 2
    s_branch L_b_p2n_2
L_b_p2r_2:
    s_mov_b32 s61, 0
    buffer_load_dwordx4 v[24:27], v88, s[48:51], s61 offen offset:2048 sc1
    s_mov_b32 s61, 20480
    buffer_load_dwordx4 v[28:31], v88, s[48:51], s61 offen offset:2048 sc1
L_b_p2n_2:
    s_bitcmp1_b32 s90, 3
    s_cbranch_scc0 L_b_p2n_3
    v_max3_u32 v90, v32, v33, v34
    v_max3_u32 v91, v35, v36, v37
    v_max3_u32 v90, v90, v38, v39
    v_max_u32 v90, v90, v91
    v_cmp_eq_u32 vcc, -1, v90
    s_cbranch_vccnz L_b_p2r_3
    ds_read_b64_tr_b16 v[128:129], v92 offset:12288
    ds_read_b64_tr_b16 v[130:131], v92 offset:12800
    ds_read_b64_tr_b16 v[132:133], v93 offset:12288
    ds_read_b64_tr_b16 v[134:135], v93 offset:12800
    ds_read_b64_tr_b16 v[136:137], v94 offset:12288
    ds_read_b64_tr_b16 v[138:139], v94 offset:12800
    ds_read_b64_tr_b16 v[140:141], v95 offset:12288
    ds_read_b64_tr_b16 v[142:143], v95 offset:12800
    s_waitcnt lgkmcnt(0)
    v_mfma_f32_16x16x32_bf16 v[96:99], v[128:131], v[32:35], v[96:99]
    v_mfma_f32_16x16x32_bf16 v[112:115], v[128:131], v[36:39], v[112:115]
    v_mfma_f32_16x16x32_bf16 v[100:103], v[132:135], v[32:35], v[100:103]
    v_mfma_f32_16x16x32_bf16 v[116:119], v[132:135], v[36:39], v[116:119]
    v_mfma_f32_16x16x32_bf16 v[104:107], v[136:139], v[32:35], v[104:107]
    v_mfma_f32_16x16x32_bf16 v[120:123], v[136:139], v[36:39], v[120:123]
    v_mfma_f32_16x16x32_bf16 v[108:111], v[140:143], v[32:35], v[108:111]
    v_mfma_f32_16x16x32_bf16 v[124:127], v[140:143], v[36:39], v[124:127]
    s_bitset0_b32 s90, 3
    s_branch L_b_p2n_3
L_b_p2r_3:
    s_mov_b32 s61, 0
    buffer_load_dwordx4 v[32:35], v88, s[48:51], s61 offen offset:3072 sc1
    s_mov_b32 s61, 20480
    buffer_load_dwordx4 v[36:39], v88, s[48:51], s61 offen offset:3072 sc1
L_b_p2n_3:
    s_bitcmp1_b32 s90, 4
    s_cbranch_scc0 L_b_p2n_4
    v_max3_u32 v90, v40, v41, v42
    v_max3_u32 v91, v43, v44, v45
    v_max3_u32 v90, v90, v46, v47
    v_max_u32 v90, v90, v91
    v_cmp_eq_u32 vcc, -1, v90
    s_cbranch_vccnz L_b_p2r_4
    ds_read_b64_tr_b16 v[128:129], v92 offset:16384
    ds_read_b64_tr_b16 v[130:131], v92 offset:16896
    ds_read_b64_tr_b16 v[132:133], v93 offset:16384
    ds_read_b64_tr_b16 v[134:135], v93 offset:16896
    ds_read_b64_tr_b16 v[136:137], v94 offset:16384
    ds_read_b64_tr_b16 v[138:139], v94 offset:16896
    ds_read_b64_tr_b16 v[140:141], v95 offset:16384
    ds_read_b64_tr_b16 v[142:143], v95 offset:16896
    s_waitcnt lgkmcnt(0)
    v_mfma_f32_16x16x32_bf16 v[96:99], v[128:131], v[40:43], v[96:99]
    v_mfma_f32_16x16x32_bf16 v[112:115], v[128:131], v[44:47], v[112:115]
    v_mfma_f32_16x16x32_bf16 v[100:103], v[132:135], v[40:43], v[100:103]
    v_mfma_f32_16x16x32_bf16 v[116:119], v[132:135], v[44:47], v[116:119]
    v_mfma_f32_16x16x32_bf16 v[104:107], v[136:139], v[40:43], v[104:107]
    v_mfma_f32_16x16x32_bf16 v[120:123], v[136:139], v[44:47], v[120:123]
    v_mfma_f32_16x16x32_bf16 v[108:111], v[140:143], v[40:43], v[108:111]
    v_mfma_f32_16x16x32_bf16 v[124:127], v[140:143], v[44:47], v[124:127]
    s_bitset0_b32 s90, 4
    s_branch L_b_p2n_4
L_b_p2r_4:
    s_mov_b32 s61, 4096
    buffer_load_dwordx4 v[40:43], v88, s[48:51], s61 offen offset:0 sc1
    s_mov_b32 s61, 24576
    buffer_load_dwordx4 v[44:47], v88, s[48:51], s61 offen offset:0 sc1
L_b_p2n_4:
    s_bitcmp1_b32 s90, 5
    s_cbranch_scc0 L_b_p2n_5
    v_max3_u32 v90, v48, v49, v50
    v_max3_u32 v91, v51, v52, v53
    v_max3_u32 v90, v90, v54, v55
    v_max_u32 v90, v90, v91
    v_cmp_eq_u32 vcc, -1, v90
    s_cbranch_vccnz L_b_p2r_5
    ds_read_b64_tr_b16 v[128:129], v92 offset:20480
    ds_read_b64_tr_b16 v[130:131], v92 offset:20992
    ds_read_b64_tr_b16 v[132:133], v93 offset:20480
    ds_read_b64_tr_b16 v[134:135], v93 offset:20992
    ds_read_b64_tr_b16 v[136:137], v94 offset:20480
    ds_read_b64_tr_b16 v[138:139], v94 offset:20992
    ds_read_b64_tr_b16 v[140:141], v95 offset:20480
    ds_read_b64_tr_b16 v[142:143], v95 offset:20992
    s_waitcnt lgkmcnt(0)
    v_mfma_f32_16x16x32_bf16 v[96:99], v[128:131], v[48:51], v[96:99]
    v_mfma_f32_16x16x32_bf16 v[112:115], v[128:131], v[52:55], v[112:115]
    v_mfma_f32_16x16x32_bf16 v[100:103], v[132:135], v[48:51], v[100:103]
    v_mfma_f32_16x16x32_bf16 v[116:119], v[132:135], v[52:55], v[116:119]
    v_mfma_f32_16x16x32_bf16 v[104:107], v[136:139], v[48:51], v[104:107]
    v_mfma_f32_16x16x32_bf16 v[120:123], v[136:139], v[52:55], v[120:123]
    v_mfma_f32_16x16x32_bf16 v[108:111], v[140:143], v[48:51], v[108:111]
    v_mfma_f32_16x16x32_bf16 v[124:127], v[140:143], v[52:55], v[124:127]
    s_bitset0_b32 s90, 5
    s_branch L_b_p2n_5
L_b_p2r_5:
    s_mov_b32 s61, 4096
    buffer_load_dwordx4 v[48:51], v88, s[48:51], s61 offen offset:1024 sc1
    s_mov_b32 s61, 24576
    buffer_load_dwordx4 v[52:55], v88, s[48:51], s61 offen offset:1024 sc1
L_b_p2n_5:
    s_bitcmp1_b32 s90, 6
    s_cbranch_scc0 L_b_p2n_6
    v_max3_u32 v90, v56, v57, v58
    v_max3_u32 v91, v59, v60, v61
    v_max3_u32 v90, v90, v62, v63
    v_max_u32 v90, v90, v91
    v_cmp_eq_u32 vcc, -1, v90
    s_cbranch_vccnz L_b_p2r_6
    ds_read_b64_tr_b16 v[128:129], v92 offset:24576
    ds_read_b64_tr_b16 v[130:131], v92 offset:25088
    ds_read_b64_tr_b16 v[132:133], v93 offset:24576
    ds_read_b64_tr_b16 v[134:135], v93 offset:25088
    ds_read_b64_tr_b16 v[136:137], v94 offset:24576
    ds_read_b64_tr_b16 v[138:139], v94 offset:25088
    ds_read_b64_tr_b16 v[140:141], v95 offset:24576
    ds_read_b64_tr_b16 v[142:143], v95 offset:25088
    s_waitcnt lgkmcnt(0)
    v_mfma_f32_16x16x32_bf16 v[96:99], v[128:131], v[56:59], v[96:99]
    v_mfma_f32_16x16x32_bf16 v[112:115], v[128:131], v[60:63], v[112:115]
    v_mfma_f32_16x16x32_bf16 v[100:103], v[132:135], v[56:59], v[100:103]
    v_mfma_f32_16x16x32_bf16 v[116:119], v[132:135], v[60:63], v[116:119]
    v_mfma_f32_16x16x32_bf16 v[104:107], v[136:139], v[56:59], v[104:107]
    v_mfma_f32_16x16x32_bf16 v[120:123], v[136:139], v[60:63], v[120:123]
    v_mfma_f32_16x16x32_bf16 v[108:111], v[140:143], v[56:59], v[108:111]
    v_mfma_f32_16x16x32_bf16 v[124:127], v[140:143], v[60:63], v[124:127]
    s_bitset0_b32 s90, 6
    s_branch L_b_p2n_6
L_b_p2r_6:
    s_mov_b32 s61, 4096
    buffer_load_dwordx4 v[56:59], v88, s[48:51], s61 offen offset:2048 sc1
    s_mov_b32 s61, 24576
    buffer_load_dwordx4 v[60:63], v88, s[48:51], s61 offen offset:2048 sc1
L_b_p2n_6:
    s_bitcmp1_b32 s90, 7
    s_cbranch_scc0 L_b_p2n_7
    v_max3_u32 v90, v64, v65, v66
    v_max3_u32 v91, v67, v68, v69
    v_max3_u32 v90, v90, v70, v71
    v_max_u32 v90, v90, v91
    v_cmp_eq_u32 vcc, -1, v90
    s_cbranch_vccnz L_b_p2r_7
    ds_read_b64_tr_b16 v[128:129], v92 offset:28672
    ds_read_b64_tr_b16 v[130:131], v92 offset:29184
    ds_read_b64_tr_b16 v[132:133], v93 offset:28672
    ds_read_b64_tr_b16 v[134:135], v93 offset:29184
    ds_read_b64_tr_b16 v[136:137], v94 offset:28672
    ds_read_b64_tr_b16 v[138:139], v94 offset:29184
    ds_read_b64_tr_b16 v[140:141], v95 offset:28672
    ds_read_b64_tr_b16 v[142:143], v95 offset:29184
    s_waitcnt lgkmcnt(0)
    v_mfma_f32_16x16x32_bf16 v[96:99], v[128:131], v[64:67], v[96:99]
    v_mfma_f32_16x16x32_bf16 v[112:115], v[128:131], v[68:71], v[112:115]
    v_mfma_f32_16x16x32_bf16 v[100:103], v[132:135], v[64:67], v[100:103]
    v_mfma_f32_16x16x32_bf16 v[116:119], v[132:135], v[68:71], v[116:119]
    v_mfma_f32_16x16x32_bf16 v[104:107], v[136:139], v[64:67], v[104:107]
    v_mfma_f32_16x16x32_bf16 v[120:123], v[136:139], v[68:71], v[120:123]
    v_mfma_f32_16x16x32_bf16 v[108:111], v[140:143], v[64:67], v[108:111]
    v_mfma_f32_16x16x32_bf16 v[124:127], v[140:143], v[68:71], v[124:127]
    s_bitset0_b32 s90, 7
    s_branch L_b_p2n_7
L_b_p2r_7:
    s_mov_b32 s61, 4096
    buffer_load_dwordx4 v[64:67], v88, s[48:51], s61 offen offset:3072 sc1
    s_mov_b32 s61, 24576
    buffer_load_dwordx4 v[68:71], v88, s[48:51], s61 offen offset:3072 sc1
L_b_p2n_7:
    s_bitcmp1_b32 s90, 8
    s_cbranch_scc0 L_b_p2n_8
    v_max3_u32 v90, v72, v73, v74
    v_max3_u32 v91, v75, v76, v77
    v_max3_u32 v90, v90, v78, v79
    v_max_u32 v90, v90, v91
    v_cmp_eq_u32 vcc, -1, v90
    s_cbranch_vccnz L_b_p2r_8
    ds_read_b64_tr_b16 v[128:129], v92 offset:32768
    ds_read_b64_tr_b16 v[130:131], v92 offset:33280
    ds_read_b64_tr_b16 v[132:133], v93 offset:32768
    ds_read_b64_tr_b16 v[134:135], v93 offset:33280
    ds_read_b64_tr_b16 v[136:137], v94 offset:32768
    ds_read_b64_tr_b16 v[138:139], v94 offset:33280
    ds_read_b64_tr_b16 v[140:141], v95 offset:32768
    ds_read_b64_tr_b16 v[142:143], v95 offset:33280
    s_waitcnt lgkmcnt(0)
    v_mfma_f32_16x16x32_bf16 v[96:99], v[128:131], v[72:75], v[96:99]
    v_mfma_f32_16x16x32_bf16 v[112:115], v[128:131], v[76:79], v[112:115]
    v_mfma_f32_16x16x32_bf16 v[100:103], v[132:135], v[72:75], v[100:103]
    v_mfma_f32_16x16x32_bf16 v[116:119], v[132:135], v[76:79], v[116:119]
    v_mfma_f32_16x16x32_bf16 v[104:107], v[136:139], v[72:75], v[104:107]
    v_mfma_f32_16x16x32_bf16 v[120:123], v[136:139], v[76:79], v[120:123]
    v_mfma_f32_16x16x32_bf16 v[108:111], v[140:143], v[72:75], v[108:111]
    v_mfma_f32_16x16x32_bf16 v[124:127], v[140:143], v[76:79], v[124:127]
    s_bitset0_b32 s90, 8
    s_branch L_b_p2n_8
L_b_p2r_8:
    s_mov_b32 s61, 8192
    buffer_load_dwordx4 v[72:75], v88, s[48:51], s61 offen offset:0 sc1
    s_mov_b32 s61, 28672
    buffer_load_dwordx4 v[76:79], v88, s[48:51], s61 offen offset:0 sc1
L_b_p2n_8:
    s_bitcmp1_b32 s90, 9
    s_cbranch_scc0 L_b_p2n_9
    v_max3_u32 v90, v80, v81, v82
    v_max3_u32 v91, v83, v84, v85
    v_max3_u32 v90, v90, v86, v87
    v_max_u32 v90, v90, v91
    v_cmp_eq_u32 vcc, -1, v90
    s_cbranch_vccnz L_b_p2r_9
    ds_read_b64_tr_b16 v[128:129], v92 offset:36864
    ds_read_b64_tr_b16 v[130:131], v92 offset:37376
    ds_read_b64_tr_b16 v[132:133], v93 offset:36864
    ds_read_b64_tr_b16 v[134:135], v93 offset:37376
    ds_read_b64_tr_b16 v[136:137], v94 offset:36864
    ds_read_b64_tr_b16 v[138:139], v94 offset:37376
    ds_read_b64_tr_b16 v[140:141], v95 offset:36864
    ds_read_b64_tr_b16 v[142:143], v95 offset:37376
    s_waitcnt lgkmcnt(0)
    v_mfma_f32_16x16x32_bf16 v[96:99], v[128:131], v[80:83], v[96:99]
    v_mfma_f32_16x16x32_bf16 v[112:115], v[128:131], v[84:87], v[112:115]
    v_mfma_f32_16x16x32_bf16 v[100:103], v[132:135], v[80:83], v[100:103]
    v_mfma_f32_16x16x32_bf16 v[116:119], v[132:135], v[84:87], v[116:119]
    v_mfma_f32_16x16x32_bf16 v[104:107], v[136:139], v[80:83], v[104:107]
    v_mfma_f32_16x16x32_bf16 v[120:123], v[136:139], v[84:87], v[120:123]
    v_mfma_f32_16x16x32_bf16 v[108:111], v[140:143], v[80:83], v[108:111]
    v_mfma_f32_16x16x32_bf16 v[124:127], v[140:143], v[84:87], v[124:127]
    s_bitset0_b32 s90, 9
    s_branch L_b_p2n_9
L_b_p2r_9:
    s_mov_b32 s61, 8192
    buffer_load_dwordx4 v[80:83], v88, s[48:51], s61 offen offset:1024 sc1
    s_mov_b32 s61, 28672
    buffer_load_dwordx4 v[84:87], v88, s[48:51], s61 offen offset:1024 sc1
L_b_p2n_9:
    s_cmp_eq_u32 s90, 0
    s_cbranch_scc1 L_b_ok2
    s_add_u32 s101, s101, 1
    s_cmp_le_u32 s101, 16384
    s_cbranch_scc1 L_b_p2
    s_waitcnt vmcnt(0)
L_b_ok2:
    s_lshl_b32 s60, s37, 12
    s_add_u32 s60, s60, 81920
    v_lshl_add_u32 v4, v1, 4, s60
    s_xor_b32 s61, s37, 4
    s_lshl_b32 s61, s61, 12
    s_add_u32 s61, s61, 81920
    v_lshl_add_u32 v5, v1, 4, s61
    s_lshl_b32 s60, s92, 7
    s_lshl_b32 s61, s95, 5
    s_add_u32 s60, s60, s61
    s_lshl_b32 s61, s96, 4
    s_add_u32 s60, s60, s61
    v_and_b32 v6, 7, v2
    v_add_u32 v6, s60, v6
    v_mul_u32_u24 v6, 2560, v6
    v_lshrrev_b32 v7, 3, v2
    v_lshl_add_u32 v6, v7, 6, v6
    v_and_b32 v7, 1, v3
    v_lshl_add_u32 v6, v7, 5, v6
    v_lshrrev_b32 v7, 1, v3
    v_lshl_add_u32 v6, v7, 4, v6
    s_lshl_b32 s60, s93, 7
    s_add_u32 s60, s60, 1280
    v_add_u32 v6, s60, v6
    s_cmp_eq_u32 s96, 0
    s_cbranch_scc1 L_b_red0
    ds_write_b128 v4, v[96:99] offset:0
    ds_write_b128 v4, v[100:103] offset:1024
    ds_write_b128 v4, v[104:107] offset:2048
    ds_write_b128 v4, v[108:111] offset:3072
    s_waitcnt lgkmcnt(0)
    s_barrier
    ds_read_b128 v[8:11], v5 offset:0
    ds_read_b128 v[12:15], v5 offset:1024
    ds_read_b128 v[16:19], v5 offset:2048
    ds_read_b128 v[20:23], v5 offset:3072
    s_waitcnt lgkmcnt(3)
    v_pk_add_f32 v[112:113], v[112:113], v[8:9]
    v_pk_add_f32 v[114:115], v[114:115], v[10:11]
    s_waitcnt lgkmcnt(2)
    v_pk_add_f32 v[116:117], v[116:117], v[12:13]
    v_pk_add_f32 v[118:119], v[118:119], v[14:15]
    v_cvt_pk_bf16_f32 v24, v112, v113
    v_cvt_pk_bf16_f32 v25, v114, v115
    v_cvt_pk_bf16_f32 v26, v116, v117
    v_cvt_pk_bf16_f32 v27, v118, v119
    s_nop 0
    v_permlane16_swap_b32 v24, v26
    v_permlane16_swap_b32 v25, v27
    s_waitcnt lgkmcnt(1)
    v_pk_add_f32 v[120:121], v[120:121], v[16:17]
    v_pk_add_f32 v[122:123], v[122:123], v[18:19]
    s_waitcnt lgkmcnt(0)
    v_pk_add_f32 v[124:125], v[124:125], v[20:21]
    v_pk_add_f32 v[126:127], v[126:127], v[22:23]
    v_cvt_pk_bf16_f32 v28, v120, v121
    v_cvt_pk_bf16_f32 v29, v122, v123
    v_cvt_pk_bf16_f32 v30, v124, v125
    v_cvt_pk_bf16_f32 v31, v126, v127
    s_nop 0
    v_permlane16_swap_b32 v28, v30
    v_permlane16_swap_b32 v29, v31
    v_cmp_gt_u32 vcc, 8, v2
    v_mov_b32_dpp v32, v24 row_ror:8 row_mask:0xf bank_mask:0xf
    v_mov_b32_dpp v36, v28 row_ror:8 row_mask:0xf bank_mask:0xf
    v_mov_b32_dpp v33, v25 row_ror:8 row_mask:0xf bank_mask:0xf
    v_mov_b32_dpp v37, v29 row_ror:8 row_mask:0xf bank_mask:0xf
    v_mov_b32_dpp v34, v26 row_ror:8 row_mask:0xf bank_mask:0xf
    v_mov_b32_dpp v38, v30 row_ror:8 row_mask:0xf bank_mask:0xf
    v_mov_b32_dpp v35, v27 row_ror:8 row_mask:0xf bank_mask:0xf
    v_mov_b32_dpp v39, v31 row_ror:8 row_mask:0xf bank_mask:0xf
    v_cndmask_b32 v36, v36, v24, vcc
    v_cndmask_b32 v32, v28, v32, vcc
    v_cndmask_b32 v37, v37, v25, vcc
    v_cndmask_b32 v33, v29, v33, vcc
    v_cndmask_b32 v38, v38, v26, vcc
    v_cndmask_b32 v34, v30, v34, vcc
    v_cndmask_b32 v39, v39, v27, vcc
    v_cndmask_b32 v35, v31, v35, vcc
    s_mov_b32 s60, 20480
    buffer_store_dwordx4 v[36:39], v6, s[56:59], 0 offen
    buffer_store_dwordx4 v[32:35], v6, s[56:59], s60 offen
    s_branch L_b_done
L_b_red0:
    ds_write_b128 v4, v[112:115] offset:0
    ds_write_b128 v4, v[116:119] offset:1024
    ds_write_b128 v4, v[120:123] offset:2048
    ds_write_b128 v4, v[124:127] offset:3072
    s_waitcnt lgkmcnt(0)
    s_barrier
    ds_read_b128 v[8:11], v5 offset:0
    ds_read_b128 v[12:15], v5 offset:1024
    ds_read_b128 v[16:19], v5 offset:2048
    ds_read_b128 v[20:23], v5 offset:3072
    s_waitcnt lgkmcnt(3)
    v_pk_add_f32 v[96:97], v[96:97], v[8:9]
    v_pk_add_f32 v[98:99], v[98:99], v[10:11]
    s_waitcnt lgkmcnt(2)
    v_pk_add_f32 v[100:101], v[100:101], v[12:13]
    v_pk_add_f32 v[102:103], v[102:103], v[14:15]
    v_cvt_pk_bf16_f32 v24, v96, v97
    v_cvt_pk_bf16_f32 v25, v98, v99
    v_cvt_pk_bf16_f32 v26, v100, v101
    v_cvt_pk_bf16_f32 v27, v102, v103
    s_nop 0
    v_permlane16_swap_b32 v24, v26
    v_permlane16_swap_b32 v25, v27
    s_waitcnt lgkmcnt(1)
    v_pk_add_f32 v[104:105], v[104:105], v[16:17]
    v_pk_add_f32 v[106:107], v[106:107], v[18:19]
    s_waitcnt lgkmcnt(0)
    v_pk_add_f32 v[108:109], v[108:109], v[20:21]
    v_pk_add_f32 v[110:111], v[110:111], v[22:23]
    v_cvt_pk_bf16_f32 v28, v104, v105
    v_cvt_pk_bf16_f32 v29, v106, v107
    v_cvt_pk_bf16_f32 v30, v108, v109
    v_cvt_pk_bf16_f32 v31, v110, v111
    s_nop 0
    v_permlane16_swap_b32 v28, v30
    v_permlane16_swap_b32 v29, v31
    v_cmp_gt_u32 vcc, 8, v2
    v_mov_b32_dpp v32, v24 row_ror:8 row_mask:0xf bank_mask:0xf
    v_mov_b32_dpp v36, v28 row_ror:8 row_mask:0xf bank_mask:0xf
    v_mov_b32_dpp v33, v25 row_ror:8 row_mask:0xf bank_mask:0xf
    v_mov_b32_dpp v37, v29 row_ror:8 row_mask:0xf bank_mask:0xf
    v_mov_b32_dpp v34, v26 row_ror:8 row_mask:0xf bank_mask:0xf
    v_mov_b32_dpp v38, v30 row_ror:8 row_mask:0xf bank_mask:0xf
    v_mov_b32_dpp v35, v27 row_ror:8 row_mask:0xf bank_mask:0xf
    v_mov_b32_dpp v39, v31 row_ror:8 row_mask:0xf bank_mask:0xf
    v_cndmask_b32 v36, v36, v24, vcc
    v_cndmask_b32 v32, v28, v32, vcc
    v_cndmask_b32 v37, v37, v25, vcc
    v_cndmask_b32 v33, v29, v33, vcc
    v_cndmask_b32 v38, v38, v26, vcc
    v_cndmask_b32 v34, v30, v34, vcc
    v_cndmask_b32 v39, v39, v27, vcc
    v_cndmask_b32 v35, v31, v35, vcc
    s_mov_b32 s60, 20480
    buffer_store_dwordx4 v[36:39], v6, s[56:59], 0 offen
    buffer_store_dwordx4 v[32:35], v6, s[56:59], s60 offen
L_b_done:
L_end:
    s_endpgm

.section .rodata,"a"
.p2align 6
.amdhsa_kernel concat_heads__ssm_conv_s4d__linear_kernel_hedgehog__prompt_kernel
  .amdhsa_next_free_vgpr 168
  .amdhsa_next_free_sgpr 102
  .amdhsa_accum_offset 168
  .amdhsa_group_segment_fixed_size 0
  .amdhsa_kernarg_size 112
  .amdhsa_user_sgpr_count 2
  .amdhsa_user_sgpr_kernarg_segment_ptr 1
  .amdhsa_system_sgpr_workgroup_id_x 1
.end_amdhsa_kernel
```
